```python
import torch

def _softmax(x, axis=-1):
    return torch.softmax(x, dim=axis)
def _gelu(x):
    return torch.nn.functional.gelu(x, approximate="tanh")
def _silu(x):
    return torch.nn.functional.silu(x)
def _sigmoid(x):
    return torch.sigmoid(x)
def _layernorm(x, axis=-1, eps=1e-5):
    m = x.mean(dim=axis, keepdim=True)
    v = x.var(dim=axis, keepdim=True, unbiased=False)
    return (x - m) / torch.sqrt(v + eps)
def _scatter_add(tgt, idx, src, axis=0):
    return tgt.clone().index_add_(axis, idx, src)
def _segment_sum(src, seg, n):
    out = torch.zeros((n,) + src.shape[1:], dtype=src.dtype)
    return out.index_add_(0, seg, src)
def _pad(x, pw):
    flat = tuple(v for pair in reversed(pw) for v in pair)
    return torch.nn.functional.pad(x, flat)

kernel_name = 'gated_mix__sliding_block__dense_activation_silu__prompt'

def setup_inputs():

    _w = (lambda a: (lambda t: t.to(torch.bfloat16) if t.is_floating_point() else t)(torch.as_tensor(a)))
    def _A_setup():
        B, S, D = 1, 2048, 512
        return {
            "x": _w((lambda *s: torch.randn(*s, dtype=torch.bfloat16) * 0.2)(B, S, D)),
            "wqkv": _w((lambda *s: torch.randn(*s, dtype=torch.bfloat16) * 0.2)(D, 3 * D)),
            "wo": _w((lambda *s: torch.randn(*s, dtype=torch.bfloat16) * 0.2)(D, D)),
        }
    _A_in = _A_setup()

    def _B_setup():
        B, S, D, F = 1, 2048, 512, 1376
        return {
            "x": _w((lambda *s: torch.randn(*s, dtype=torch.bfloat16) * 0.2)(B, S, D)),
            "w1": _w((lambda *s: torch.randn(*s, dtype=torch.bfloat16) * 3.2)(D, F) * (D ** -0.5)),
            "w2": _w((lambda *s: torch.randn(*s, dtype=torch.bfloat16) * 3.2)(F, D) * (F ** -0.5)),
        }
    _B_in = _B_setup()

    return {
        "A_x": _A_in["x"],
        "A_wqkv": _A_in["wqkv"],
        "A_wo": _A_in["wo"],
        "B_x": _B_in["x"],
        "B_w1": _B_in["w1"],
        "B_w2": _B_in["w2"],
        "gate_w": _w((lambda *s: torch.randn(*s, dtype=torch.bfloat16) * 0.2)(512) * 16.0),
    }

def reference(A_x, A_wqkv, A_wo, B_x, B_w1, B_w2, gate_w):
    def _A_ref(x, wqkv, wo):
        B, S, D = x.shape
        H = 32; Dh = D // H; W = 256
        qkv = (lambda x, *d: x.permute(*d))((x @ wqkv).reshape(B, S, 3, H, Dh), 2, 0, 3, 1, 4)
        q, k, v = qkv[0], qkv[1], qkv[2]
        scores = torch.einsum("bhqd,bhkd->bhqk", q, k) * (Dh ** -0.5)
        idx = torch.arange(S)
        mask = (idx[:, None] - idx[None, :] >= 0) & (idx[:, None] - idx[None, :] < W)
        scores = torch.where(mask[None, None], scores, -1e9)
        p = _softmax(scores, axis=-1)
        o = torch.einsum("bhqk,bhkd->bhqd", p, v)
        return (lambda x, *d: x.permute(*d))(o, 0, 2, 1, 3).reshape(B, S, D) @ wo

    def _B_ref(x, w1, w2):
        h = torch.einsum("bsd,df->bsf", x, w1)
        h = _silu(h)
        out = torch.einsum("bsf,fd->bsd", h, w2)
        return out

    x = A_x
    g = _sigmoid((x * gate_w).sum(-1, keepdims=True))
    a = _A_ref(x, A_wqkv, A_wo)
    b = _B_ref(x, B_w1, B_w2)
    return g * a + (1 - g) * b
```

```asm
; @launch grid=(256,1,1) block=(256,1,1) lds=163840
.amdgcn_target "amdgcn-amd-amdhsa--gfx950"
.text
.globl gated_mix__sliding_block__dense_activation_silu__prompt_kernel
.p2align 12
.p2align 8
.type gated_mix__sliding_block__dense_activation_silu__prompt_kernel,@function
gated_mix__sliding_block__dense_activation_silu__prompt_kernel:
    s_cmp_ge_u32 s2, 0x100
    s_cbranch_scc1 L_end
    s_load_dwordx2 s[4:5], s[0:1], 0
    s_load_dwordx2 s[8:9], s[0:1], 8
    s_load_dwordx16 s[48:63], s[0:1], 16
    s_lshr_b32 s41, s2, 3
    s_getpc_b64 s[46:47]
L_pc:
    v_lshrrev_b32 v250, 4, v0
    v_lshl_add_u32 v250, s41, 4, v250
    v_min_u32 v250, (L_end-L_pc)/64, v250
    v_mad_u64_u32 v[250:251], vcc, v250, 64, s[46:47]
    global_load_dword v252, v[250:251], off
    v_lshrrev_b32 v234, 6, v0
    v_and_b32 v228, 63, v0
    v_readfirstlane_b32 s64, v234
    s_and_b32 s73, s2, 1
    s_and_b32 s92, s41, 7
    s_lshl3_add_u32 s65, s73, s92
    s_bfe_u32 s73, s2, 0x20001
    s_lshr_b32 s92, s2, 6
    s_lshl2_add_u32 s66, s73, s92
    s_add_u32 s93, s92, s41
    s_and_b32 s93, s93, 1
    s_lshl_b32 s93, s93, 2
    s_lshl1_add_u32 s73, s2, s2
    s_and_b32 s73, s73, 2
    s_or_b32 s93, s93, s73
    s_lshl2_add_u32 s42, s65, s64
    s_lshl_b32 s69, s64, 12
    s_lshl_b32 s67, s64, 11
    v_lshrrev_b32 v231, 3, v228
    v_lshrrev_b32 v232, 4, v228
    v_and_b32 v234, 7, v228
    v_xor_b32 v235, v234, v232
    v_lshlrev_b32 v235, 4, v235
    v_lshl_add_u32 v235, v231, 10, v235
    v_lshl_add_u32 v3, s42, 15, v235
    v_xor_b32 v4, 64, v3
    v_add_u32 v4, 7168, v4
    v_add_u32 v5, 14336, v3
    v_add_u32 v6, 14336, v4
    v_bfe_u32 v235, v228, 4, 1
    v_lshlrev_b32 v235, 2, v235
    v_xor_b32 v235, v234, v235
    v_lshlrev_b32 v233, 4, v235
    s_and_b32 s73, s66, 1
    s_lshr_b32 s43, s66, 1
    s_lshl3_add_u32 s73, s73, s43
    s_mul_i32 s92, s64, 384
    s_add_u32 s73, s73, s92
    s_add_u32 s73, s73, 8
    s_lshl_b32 s73, s73, 7
    v_mul_u32_u24 v235, 3072, v231
    v_add3_u32 v7, v235, v233, s73
    v_add_u32 v8, 23552, v7
    s_mov_b32 s6, 2097152
    s_mov_b32 s7, 0x20000
    s_mov_b32 s10, 1572864
    s_mov_b32 s11, s7
    v_and_b32 v230, 31, v228
    v_lshlrev_b32 v39, 4, v230
    s_movk_i32 s34, 1024
    s_mov_b32 s35, s7
    s_mul_i32 s72, s93, 128
    s_add_u32 m0, s69, 0x0
    s_waitcnt lgkmcnt(0)
    buffer_load_dwordx4 v3, s[4:7], s72 offen offset:0 lds
    buffer_load_dwordx4 v4, s[4:7], s72 offen offset:1024 lds
    s_mul_i32 s72, s93, 196608
    s_add_u32 m0, s67, 0x18000
    s_nop 0
    buffer_load_dwordx4 v7, s[8:11], s72 offen offset:0 lds
    buffer_load_dwordx4 v8, s[8:11], s72 offen offset:1024 lds
    s_mul_i32 s72, s93, 128
    s_add_u32 m0, s69, 0x0
    s_nop 0
    buffer_load_dwordx4 v5, s[4:7], s72 offen offset:2048 lds
    buffer_load_dwordx4 v6, s[4:7], s72 offen offset:3072 lds
    s_mov_b64 s[32:33], s[56:57]
    s_mov_b64 s[24:25], s[62:63]
    s_mov_b64 s[12:13], s[52:53]
    s_mov_b64 s[20:21], s[48:49]
    s_mov_b64 s[16:17], s[54:55]
    s_mov_b64 s[28:29], s[58:59]
    s_mov_b64 s[36:37], s[60:61]
    s_mov_b32 s26, 0x1000000
    s_mov_b32 s27, s7
    v_lshlrev_b32 v1, 4, v228
    s_cmp_eq_u32 s66, 15
    s_cselect_b32 s14, 0, 1409024
    s_cselect_b32 s94, 1, 0
    s_cmp_eq_u32 s94, 0
    s_cbranch_scc1 L_nozero
    v_mov_b32 v244, 0
    v_mov_b32 v245, 0
    v_lshrrev_b32 v246, 1, v1
    s_lshl2_add_u32 s97, s65, s64
    s_lshl_b32 s97, s97, 9
    s_add_u32 s97, s97, 0x420000
    buffer_store_dwordx2 v[244:245], v246, s[24:27], s97 offen sc1
L_nozero:
    s_mov_b32 s18, 1409024
    s_mov_b32 s19, s7
    s_mov_b32 s22, 524288
    s_xor_b32 s72, s93, 1
    s_mul_i32 s72, s72, 128
    s_add_u32 m0, s69, 0x4000
    s_nop 0
    buffer_load_dwordx4 v3, s[4:7], s72 offen offset:0 lds
    s_mov_b32 s23, s7
    s_mov_b32 s30, 2097152
    s_mov_b32 s31, s7
    s_mov_b32 s15, s7
    buffer_load_dwordx4 v4, s[4:7], s72 offen offset:1024 lds
    s_and_b32 s40, s2, 7
    v_lshrrev_b32 v229, 5, v228
    v_lshrrev_b32 v234, 1, v230
    v_and_b32 v234, 7, v234
    v_xor_b32 v234, v234, v229
    v_lshlrev_b32 v234, 4, v234
    v_lshl_add_u32 v234, v230, 7, v234
    v_add_u32 v18, s69, v234
    v_xor_b32 v19, 32, v18
    v_xor_b32 v20, 64, v18
    v_xor_b32 v21, 0x60, v18
    v_bfe_u32 v237, v228, 2, 2
    buffer_load_dwordx4 v5, s[4:7], s72 offen offset:2048 lds
    v_and_b32 v234, 3, v228
    v_lshlrev_b32 v234, 3, v234
    v_and_b32 v235, 1, v232
    v_lshl_add_u32 v238, v235, 5, v234
    v_and_b32 v235, 1, v231
    v_lshlrev_b32 v239, 6, v235
    v_lshl_add_u32 v236, v229, 3, v237
    v_lshl_add_u32 v234, v236, 7, v238
    v_add_u32 v234, 98304, v234
    v_add_u32 v23, v234, v239
    s_and_b32 s73, s66, 1
    s_lshl_b32 s73, s73, 6
    v_xor_b32 v23, s73, v23
    v_xor_b32 v24, 64, v23
    s_lshl_b32 s73, s66, 8
    s_add_u32 s73, s73, s69
    buffer_load_dwordx4 v6, s[4:7], s72 offen offset:3072 lds
    v_lshl_add_u32 v22, v228, 2, s73
    s_and_b32 s73, s66, 7
    s_lshl3_add_u32 s73, s93, s73
    s_lshl_b32 s73, s73, 4
    s_add_u32 s73, s73, 155648
    v_lshlrev_b32 v234, 2, v230
    v_xor_b32 v220, s73, v234
    v_xor_b32 v222, 0x100, v220
    v_xor_b32 v224, 0x200, v220
    v_xor_b32 v226, 0x300, v220
    s_mov_b32 s86, 1
    v_mul_u32_u24 v234, 192, v236
    v_add_u32 v234, v234, v238
    v_add_u32 v25, 32768, v234
    v_add_u32 v26, 98304, v234
    v_lshl_add_u32 v234, v236, 6, v238
    v_add_u32 v27, 81920, v234
    v_add_u32 v28, 147456, v234
    s_mul_i32 s68, s64, 3072
    s_mul_i32 s73, s64, 44032
    s_mul_i32 s92, s66, 192
    s_add_u32 s73, s73, s92
    v_add_u32 v234, 0, v228
    v_mul_u32_u24 v235, 0xaaab, v234
    v_lshrrev_b32 v235, 19, v235
    v_mul_u32_u24 v9, 12, v235
    v_sub_u32 v234, v234, v9
    v_mul_u32_u24 v235, 2752, v235
    v_lshl_add_u32 v234, v234, 4, v235
    v_add_u32 v9, s73, v234
    v_add_u32 v234, 64, v228
    v_mul_u32_u24 v235, 0xaaab, v234
    v_lshrrev_b32 v235, 19, v235
    v_mul_u32_u24 v10, 12, v235
    v_sub_u32 v234, v234, v10
    v_mul_u32_u24 v235, 2752, v235
    v_lshl_add_u32 v234, v234, 4, v235
    v_add_u32 v10, s73, v234
    v_subrev_u32 v10, 1024, v10
    v_add_u32 v234, 128, v228
    v_mul_u32_u24 v235, 0xaaab, v234
    v_lshrrev_b32 v235, 19, v235
    v_mul_u32_u24 v11, 12, v235
    v_sub_u32 v234, v234, v11
    v_mul_u32_u24 v235, 2752, v235
    v_lshl_add_u32 v234, v234, 4, v235
    v_add_u32 v11, s73, v234
    v_subrev_u32 v11, 2048, v11
    s_mul_i32 s73, s64, 98304
    s_lshl_b32 s92, s66, 6
    s_add_u32 s73, s73, s92
    v_lshrrev_b32 v234, 2, v228
    v_mul_u32_u24 v234, 3072, v234
    v_and_b32 v235, 3, v228
    v_lshl_add_u32 v234, v235, 4, v234
    v_add_u32 v12, s73, v234
    v_add_u32 v13, 48128, v12
    s_lshr_b32 s44, s64, 1
    s_and_b32 s45, s64, 1
    s_lshr_b32 s47, s41, 2
    s_lshl_b32 s73, s40, 2
    s_and_b32 s92, s41, 3
    s_add_u32 s73, s73, s92
    s_lshl_b32 s46, s73, 1
    s_add_u32 s46, s46, s45
    s_lshl_b32 s73, s45, 13
    s_lshl_b32 s92, s47, 7
    s_add_u32 s73, s73, s92
    v_and_b32 v234, 7, v228
    v_lshlrev_b32 v235, 1, v232
    v_xor_b32 v234, v234, v235
    v_lshlrev_b32 v233, 4, v234
    v_lshl_add_u32 v234, v231, 10, v233
    v_add_u32 v14, s73, v234
    v_add_u32 v15, 15360, v14
    v_add_u32 v16, 30720, v14
    v_add_u32 v17, 46080, v14
    s_mul_i32 s95, s44, 688128
    s_lshl_b32 s96, s44, 18
    s_brev_b32 s73, s47
    s_lshr_b32 s73, s73, 29
    s_and_b32 s73, s73, 4
    s_lshl_b32 s1, s73, 12
    s_lshl_b32 s3, s73, 16
    s_mul_i32 s71, s64, 2560
    s_add_u32 s71, s71, 20480
    s_add_u32 s70, s67, 114688
    s_bitcmp1_b32 s66, 0
    s_cselect_b32 s70, s70, s71
    s_mul_i32 s71, s64, 5120
    v_mov_b32 v235, 0x2000000
    v_lshlrev_b32 v234, 4, v229
    v_cmp_eq_u32 vcc, 31, v230
    s_nop 1
    v_cndmask_b32 v38, v235, v234, vcc
    v_add_u32 v234, s67, v1
    v_add_u32 v29, 98304, v234
    v_and_b32 v234, 15, v228
    v_lshlrev_b32 v234, 4, v234
    s_mov_b64 exec, 0
    s_cmp_eq_u32 s64, 1
    s_cbranch_scc1 Lt_0
    s_cmp_eq_u32 s64, 2
    s_cbranch_scc1 Lt_1
    s_cmp_eq_u32 s64, 3
    s_cbranch_scc1 Lt_2
    s_bitcmp1_b32 s66, 0
    s_cbranch_scc1 L_p1v
    s_branch L_p1k
Lt_back:
    s_mov_b64 exec, -1
    s_xor_b32 s72, s93, 1
    s_mul_i32 s72, s72, 196608
    s_add_u32 m0, s67, 0x1a000
    s_nop 0
    buffer_load_dwordx4 v7, s[8:11], s72 offen offset:0 lds
    buffer_load_dwordx4 v8, s[8:11], s72 offen offset:1024 lds
    v_lshrrev_b32 v219, 2, v1
    s_lshr_b32 s72, s67, 3
    s_add_u32 m0, s72, 155648
    s_nop 0
    buffer_load_dword v219, s[32:35], s72 offen lds
    s_xor_b32 s72, s93, 2
    s_mul_i32 s72, s72, 128
    s_add_u32 m0, s69, 0x8000
    s_nop 0
    buffer_load_dwordx4 v3, s[4:7], s72 offen offset:0 lds
    v_lshl_add_u32 v235, v229, 9, v234
    v_add_u32 v234, 1024, v234
    s_mul_i32 s73, s64, 2560
    v_cmp_gt_u32 vcc, 16, v230
    s_nop 1
    v_cndmask_b32 v30, v234, v235, vcc
    v_add_u32 v235, 256, v235
    v_cndmask_b32 v31, v234, v235, vcc
    buffer_load_dwordx4 v4, s[4:7], s72 offen offset:1024 lds
    v_add_u32 v30, s73, v30
    v_add_u32 v31, s73, v31
    v_lshl_add_u32 v234, v229, 3, v237
    v_lshl_add_u32 v234, v234, 7, v238
    v_and_b32 v235, 1, v232
    v_mul_u32_u24 v235, 544, v235
    v_lshrrev_b32 v239, 1, v239
    s_mul_i32 s73, s44, 8256
    v_add3_u32 v234, v234, v235, v239
    v_xor_b32 v32, s73, v234
    v_xor_b32 v33, 32, v32
    v_add_u32 v34, 65536, v32
    v_add_u32 v35, 65536, v33
    v_add_u32 v36, 131072, v32
    v_add_u32 v37, 131072, v33
    s_lshl_b32 s73, s42, 16
    s_and_b32 s92, s66, 1
    s_lshl_b32 s92, s92, 15
    s_add_u32 s73, s73, s92
    s_lshl_b32 s92, s43, 12
    s_add_u32 s73, s73, s92
    s_add_u32 s77, s73, 0x10000
    s_lshl_b32 s73, s42, 17
    s_mul_i32 s92, s66, 6144
    s_add_u32 s78, s73, s92
    s_add_u32 s78, s78, 0x500000
    s_cmp_lt_u32 s66, 14
    s_cselect_b32 s38, s78, 0x1000000
    s_cmp_lt_u32 s66, 15
    s_cselect_b32 s78, s78, 0x1000000
    buffer_load_dwordx4 v5, s[4:7], s72 offen offset:2048 lds
    s_lshl_b32 s92, s66, 11
    s_add_u32 s79, s73, s92
    s_add_u32 s79, s79, 0x518000
    s_lshl_b32 s73, s46, 17
    s_mul_i32 s92, s44, 43008
    s_add_u32 s80, s73, s92
    s_add_u32 s80, s80, 0x500000
    s_lshr_b32 s92, s96, 4
    s_add_u32 s81, s73, s92
    s_add_u32 s81, s81, 0x518000
    s_lshl4_add_u32 s73, s65, s43
    s_lshl_b32 s73, s73, 7
    s_add_u32 s82, s73, 0x420000
    s_min_u32 s73, s65, 2
    s_lshl3_add_u32 s83, s73, 8
    s_lshl3_add_u32 s73, s65, s64
    s_lshl_b32 s73, s73, 8
    s_add_u32 s84, s73, 0x420400
    s_and_b32 s73, s46, 0xfc
    s_add_u32 s73, s73, s46
    s_lshl1_add_u32 s73, s73, s44
    s_lshl_b32 s73, s73, 7
    s_add_u32 s85, s73, 0x420400
    s_lshl_b32 s73, s42, 8
    s_and_b32 s92, s66, 8
    s_add_u32 s73, s73, s92
    s_and_b32 s92, s66, 7
    s_lshl_b32 s92, s92, 5
    s_add_u32 s73, s73, s92
    s_add_u32 s87, s73, 0x8000
    s_lshl_b32 s73, s46, 8
    s_add_u32 s88, s73, 0x8000
    buffer_load_dwordx4 v6, s[4:7], s72 offen offset:3072 lds
    s_lshl_b32 s73, s46, 15
    s_lshl_b32 s92, s47, 7
    s_add_u32 s73, s73, s92
    s_lshl_b32 s92, s44, 6
    s_add_u32 s89, s73, s92
    s_mov_b32 s90, 20000
    s_mov_b32 s91, 0x42dc0000
    s_bitcmp1_b32 s66, 0
    s_cselect_b32 s91, 0x5d800000, s91
    s_lshl_b32 s73, s65, 2
    s_mul_i32 s92, s64, 2
    s_add_u32 s73, s73, s92
    s_lshl_b32 s92, s66, 11
    s_add_u32 s92, s92, 0xfff90000
    s_add_u32 s97, s42, 8
    s_lshl_b32 s76, s97, 16
    s_add_u32 s76, s76, s92
    s_bitcmp1_b32 s66, 0
    s_cselect_b32 s97, 0, 0x8800
    s_xor_b32 s76, s76, s97
    s_add_u32 s97, s73, 0
    s_lshl_b32 s74, s97, 16
    s_add_u32 s74, s74, s92
    s_cmp_ge_u32 s97, 8
    s_cselect_b32 s74, s74, 0x1000000
    s_waitcnt vmcnt(11)
    s_barrier
    ds_read_b128 a[0:3], v18 offset:0
    ds_read_b64_tr_b16 v[72:73], v23 offset:0
    ds_read_b64_tr_b16 v[74:75], v23 offset:512
    ds_read_b64_tr_b16 v[76:77], v24 offset:0
    ds_read_b64_tr_b16 v[78:79], v24 offset:512
    ds_read_b128 a[4:7], v19 offset:0
    ds_read_b64_tr_b16 v[80:81], v23 offset:2048
    ds_read_b64_tr_b16 v[82:83], v23 offset:2560
    ds_read_b64_tr_b16 v[84:85], v24 offset:2048
    ds_read_b64_tr_b16 v[86:87], v24 offset:2560
    ds_read_b128 a[8:11], v20 offset:0
    ds_read_b64_tr_b16 v[88:89], v23 offset:4096
    ds_read_b64_tr_b16 v[90:91], v23 offset:4608
    s_bitcmp1_b32 s66, 0
    s_cbranch_scc1 L_p1v
    s_branch L_p1k
Lr_gate1:
    s_load_dword s32, s[36:37], 0x0 glc
    s_sub_u32 s90, s90, 1
    s_cbranch_scc0 Lp_gate1
    s_mov_b32 s90, 0
    s_waitcnt lgkmcnt(0)
    s_branch Ld_gate1
Lr_kv2:
    s_load_dword s92, s[24:25], s82 glc
    s_sub_u32 s90, s90, 1
    s_cbranch_scc0 Lp_kv2
    s_mov_b32 s90, 0
    s_waitcnt lgkmcnt(0)
    s_branch Ld_kv2
Lr_h3:
    s_load_dword s40, s[24:25], s85 glc
    s_sub_u32 s90, s90, 1
    s_cbranch_scc0 Lp_h3
    s_mov_b32 s90, 0
    s_waitcnt lgkmcnt(0)
    s_branch Ld_h3
Lr_o4:
    s_load_dword s40, s[24:25], s85 offset:4 glc
    s_sub_u32 s90, s90, 1
    s_cbranch_scc0 Lp_o4
    s_mov_b32 s90, 0
    s_waitcnt lgkmcnt(0)
    s_branch Ld_o4
.p2align 12
L_p1k:
    s_cbranch_execz L_p1e
    s_xor_b32 s72, s93, 2
    s_mul_i32 s72, s72, 196608
    s_add_u32 m0, s67, 0x1c000
    s_waitcnt lgkmcnt(10)
    v_mfma_f32_32x32x16_bf16 v[108:123], v[72:75], a[0:3], 0
    buffer_load_dwordx4 v7, s[8:11], s72 offen offset:0 lds
    ds_read_b64_tr_b16 v[92:93], v24 offset:4096
    ds_read_b64_tr_b16 v[94:95], v24 offset:4608
    s_waitcnt lgkmcnt(10)
    v_mfma_f32_32x32x16_bf16 v[124:139], v[76:79], a[0:3], 0
    buffer_load_dwordx4 v8, s[8:11], s72 offen offset:1024 lds
    ds_read_b128 a[12:15], v21 offset:0
    ds_read_b64_tr_b16 v[96:97], v23 offset:6144
    ds_read_b64_tr_b16 v[98:99], v23 offset:6656
    s_waitcnt lgkmcnt(5)
    v_mfma_f32_32x32x16_bf16 v[108:123], v[80:83], a[4:7], v[108:123]
    ds_read_b32 v212, v22 offset:0
    ds_read_b64_tr_b16 v[100:101], v24 offset:6144
    ds_read_b64_tr_b16 v[102:103], v24 offset:6656
    s_add_u32 s97, s73, 1
    s_lshl_b32 s75, s97, 16
    s_add_u32 s75, s75, s92
    s_cmp_ge_u32 s97, 8
    s_cselect_b32 s75, s75, 0x1000000
    v_mfma_f32_32x32x16_bf16 v[124:139], v[84:87], a[4:7], v[124:139]
    v_lshlrev_b32 v234, 2, v229
    v_sub_u32 v240, v230, v234
    v_mov_b32 v241, 0xf149f2ca
    v_cmp_le_i32 s[50:51], 0, v240
    s_xor_b32 s72, s93, 3
    s_mul_i32 s72, s72, 128
    s_add_u32 m0, s69, 0xc000
    s_nop 0
    buffer_load_dwordx4 v3, s[4:7], s72 offen offset:0 lds
    v_cmp_le_i32 s[52:53], 1, v240
    v_cmp_le_i32 s[54:55], 2, v240
    v_cmp_le_i32 s[56:57], 3, v240
    v_cndmask_b32 v40, v241, 0, s[50:51]
    v_cndmask_b32 v56, 0, v241, s[50:51]
    v_cndmask_b32 v41, v241, 0, s[52:53]
    v_cndmask_b32 v57, 0, v241, s[52:53]
    v_cndmask_b32 v42, v241, 0, s[54:55]
    v_cndmask_b32 v58, 0, v241, s[54:55]
    v_cndmask_b32 v43, v241, 0, s[56:57]
    v_cndmask_b32 v59, 0, v241, s[56:57]
    v_cmp_le_i32 s[50:51], 8, v240
    v_cmp_le_i32 s[52:53], 9, v240
    v_cmp_le_i32 s[54:55], 10, v240
    v_cmp_le_i32 s[56:57], 11, v240
    v_cndmask_b32 v44, v241, 0, s[50:51]
    v_cndmask_b32 v60, 0, v241, s[50:51]
    v_cndmask_b32 v45, v241, 0, s[52:53]
    v_cndmask_b32 v61, 0, v241, s[52:53]
    v_cndmask_b32 v46, v241, 0, s[54:55]
    buffer_load_dwordx4 v4, s[4:7], s72 offen offset:1024 lds
    v_cndmask_b32 v62, 0, v241, s[54:55]
    v_cndmask_b32 v47, v241, 0, s[56:57]
    v_cndmask_b32 v63, 0, v241, s[56:57]
    v_cmp_le_i32 s[50:51], 16, v240
    v_cmp_le_i32 s[52:53], 17, v240
    v_cmp_le_i32 s[54:55], 18, v240
    v_cmp_le_i32 s[56:57], 19, v240
    v_cndmask_b32 v48, v241, 0, s[50:51]
    v_cndmask_b32 v64, 0, v241, s[50:51]
    v_cndmask_b32 v49, v241, 0, s[52:53]
    v_cndmask_b32 v65, 0, v241, s[52:53]
    v_cndmask_b32 v50, v241, 0, s[54:55]
    v_cndmask_b32 v66, 0, v241, s[54:55]
    v_cndmask_b32 v51, v241, 0, s[56:57]
    v_cndmask_b32 v67, 0, v241, s[56:57]
    v_cmp_le_i32 s[50:51], 24, v240
    buffer_load_dwordx4 v5, s[4:7], s72 offen offset:2048 lds
    v_cmp_le_i32 s[52:53], 25, v240
    v_cmp_le_i32 s[54:55], 26, v240
    v_cmp_le_i32 s[56:57], 27, v240
    v_cndmask_b32 v52, v241, 0, s[50:51]
    v_cndmask_b32 v68, 0, v241, s[50:51]
    v_cndmask_b32 v53, v241, 0, s[52:53]
    v_cndmask_b32 v69, 0, v241, s[52:53]
    v_cndmask_b32 v54, v241, 0, s[54:55]
    v_cndmask_b32 v70, 0, v241, s[54:55]
    v_cndmask_b32 v55, v241, 0, s[56:57]
    v_cndmask_b32 v71, 0, v241, s[56:57]
    s_mul_i32 s73, s64, 6
    v_add_u32 v242, s73, v232
    v_and_b32 v234, 1, v232
    v_add3_u32 v243, v234, 4, s73
    s_lshl_b32 s92, s65, 3
    buffer_load_dwordx4 v6, s[4:7], s72 offen offset:3072 lds
    v_mov_b32 v235, 0x3f803f80
    v_and_b32 v234, 11, v228
    v_cmp_eq_u32 vcc, 0, v234
    s_nop 1
    v_cndmask_b32 v235, 0, v235, vcc
    v_add_u32 v234, s92, v242
    v_cmp_le_u32 vcc, 16, v234
    s_nop 1
    v_cndmask_b32 v244, 0, v235, vcc
    v_add_u32 v234, s92, v243
    v_cmp_le_u32 vcc, 16, v234
    s_nop 1
    v_cndmask_b32 v245, 0, v235, vcc
    v_and_b32 v234, 15, v228
    v_lshlrev_b32 v234, 4, v234
    v_add_u32 v234, 1024, v234
    v_mul_u32_u24 v242, 1280, v242
    v_add_u32 v242, v242, v234
    v_mul_u32_u24 v243, 1280, v243
    v_add_u32 v243, v243, v234
    s_xor_b32 s72, s93, 3
    s_mul_i32 s72, s72, 196608
    s_add_u32 m0, s67, 0x1e000
    s_nop 0
    buffer_load_dwordx4 v7, s[8:11], s72 offen offset:0 lds
    s_waitcnt vmcnt(12)
    s_barrier
    ds_read_b128 a[16:19], v18 offset:16384
    ds_read_b64_tr_b16 v[104:105], v23 offset:8192
    ds_read_b64_tr_b16 v[106:107], v23 offset:8704
    v_mfma_f32_32x32x16_bf16 v[108:123], v[88:91], a[8:11], v[108:123]
    buffer_load_dwordx4 v8, s[8:11], s72 offen offset:1024 lds
    ds_read_b64_tr_b16 v[72:73], v24 offset:8192
    ds_read_b64_tr_b16 v[74:75], v24 offset:8704
    s_xor_b32 s72, s93, 4
    s_mul_i32 s72, s72, 128
    s_add_u32 m0, s69, 0x10000
    s_waitcnt lgkmcnt(5)
    v_mfma_f32_32x32x16_bf16 v[124:139], v[92:95], a[8:11], v[124:139]
    buffer_load_dwordx4 v3, s[4:7], s72 offen offset:0 lds
    ds_read_b128 a[20:23], v19 offset:16384
    ds_read_b64_tr_b16 v[76:77], v23 offset:10240
    ds_read_b64_tr_b16 v[78:79], v23 offset:10752
    v_mfma_f32_32x32x16_bf16 v[108:123], v[96:99], a[12:15], v[108:123]
    ds_read_b64_tr_b16 v[80:81], v24 offset:10240
    ds_read_b64_tr_b16 v[82:83], v24 offset:10752
    v_mfma_f32_32x32x16_bf16 v[124:139], v[100:103], a[12:15], v[124:139]
    buffer_load_dwordx4 v4, s[4:7], s72 offen offset:1024 lds
    ds_read_b128 a[24:27], v20 offset:16384
    ds_read_b64_tr_b16 v[84:85], v23 offset:12288
    ds_read_b64_tr_b16 v[86:87], v23 offset:12800
    s_waitcnt lgkmcnt(8)
    v_mfma_f32_32x32x16_bf16 v[108:123], v[104:107], a[16:19], v[108:123]
    ds_read_b64_tr_b16 v[88:89], v24 offset:12288
    ds_read_b64_tr_b16 v[90:91], v24 offset:12800
    v_mfma_f32_32x32x16_bf16 v[124:139], v[72:75], a[16:19], v[124:139]
    buffer_load_dwordx4 v5, s[4:7], s72 offen offset:2048 lds
    ds_read_b128 a[28:31], v21 offset:16384
    ds_read_b64_tr_b16 v[92:93], v23 offset:14336
    ds_read_b64_tr_b16 v[94:95], v23 offset:14848
    s_waitcnt lgkmcnt(8)
    v_mfma_f32_32x32x16_bf16 v[108:123], v[76:79], a[20:23], v[108:123]
    ds_read_b32 v213, v22 offset:16384
    ds_read_b64_tr_b16 v[96:97], v24 offset:14336
    ds_read_b64_tr_b16 v[98:99], v24 offset:14848
    v_mfma_f32_32x32x16_bf16 v[124:139], v[80:83], a[20:23], v[124:139]
    buffer_load_dwordx4 v6, s[4:7], s72 offen offset:3072 lds
    s_xor_b32 s72, s93, 4
    s_mul_i32 s72, s72, 196608
    s_add_u32 m0, s67, 0x20000
    s_nop 0
    buffer_load_dwordx4 v7, s[8:11], s72 offen offset:0 lds
    buffer_load_dwordx4 v8, s[8:11], s72 offen offset:1024 lds
    s_waitcnt vmcnt(12)
    s_barrier
    s_cmp_eq_u32 s94, 0
    s_cbranch_scc1 L_nogateK
    s_atomic_add s86, s[36:37], 0x0
L_nogateK:
    ds_read_b128 a[32:35], v18 offset:32768
    ds_read_b64_tr_b16 v[100:101], v23 offset:16384
    ds_read_b64_tr_b16 v[102:103], v23 offset:16896
    s_waitcnt lgkmcnt(3)
    v_mfma_f32_32x32x16_bf16 v[108:123], v[84:87], a[24:27], v[108:123]
    ds_read2_b32 v[220:221], v220 offset0:0 offset1:32
    ds_read_b64_tr_b16 v[104:105], v24 offset:16384
    ds_read_b64_tr_b16 v[106:107], v24 offset:16896
    v_mfma_f32_32x32x16_bf16 v[124:139], v[88:91], a[24:27], v[124:139]
    ds_read_b128 a[36:39], v19 offset:32768
    ds_read_b64_tr_b16 v[72:73], v23 offset:18432
    ds_read_b64_tr_b16 v[74:75], v23 offset:18944
    v_mfma_f32_32x32x16_bf16 v[108:123], v[92:95], a[28:31], v[108:123]
    ds_read2_b32 v[222:223], v222 offset0:0 offset1:32
    ds_read_b64_tr_b16 v[76:77], v24 offset:18432
    ds_read_b64_tr_b16 v[78:79], v24 offset:18944
    v_mfma_f32_32x32x16_bf16 v[124:139], v[96:99], a[28:31], v[124:139]
    ds_read_b128 a[40:43], v20 offset:32768
    ds_read_b64_tr_b16 v[80:81], v23 offset:20480
    ds_read_b64_tr_b16 v[82:83], v23 offset:20992
    v_lshlrev_b32 v247, 16, v212
    v_and_b32 v248, 0xffff0000, v212
    s_waitcnt lgkmcnt(11)
    v_lshlrev_b32 v249, 16, v220
    v_and_b32 v250, 0xffff0000, v220
    v_mfma_f32_32x32x16_bf16 v[108:123], v[100:103], a[32:35], v[108:123]
    ds_read2_b32 v[224:225], v224 offset0:0 offset1:32
    ds_read_b64_tr_b16 v[84:85], v24 offset:20480
    ds_read_b64_tr_b16 v[86:87], v24 offset:20992
    v_mul_f32 v247, v247, v249
    v_mul_f32 v248, v248, v250
    v_cvt_pk_bf16_f32 v247, v247, v248
    s_xor_b32 s72, s93, 5
    s_mul_i32 s72, s72, 128
    s_add_u32 m0, s69, 0x14000
    s_waitcnt lgkmcnt(9)
    v_mfma_f32_32x32x16_bf16 v[124:139], v[104:107], a[32:35], v[124:139]
    buffer_load_dwordx4 v3, s[4:7], s72 offen offset:0 lds
    ds_read_b128 a[44:47], v21 offset:32768
    ds_read_b64_tr_b16 v[88:89], v23 offset:22528
    ds_read_b64_tr_b16 v[90:91], v23 offset:23040
    v_mfma_f32_32x32x16_bf16 v[108:123], v[72:75], a[36:39], v[108:123]
    ds_read_b32 v214, v22 offset:32768
    ds_read2_b32 v[226:227], v226 offset0:0 offset1:32
    ds_read_b64_tr_b16 v[92:93], v24 offset:22528
    ds_read_b64_tr_b16 v[94:95], v24 offset:23040
    s_waitcnt lgkmcnt(10)
    v_mfma_f32_32x32x16_bf16 v[124:139], v[76:79], a[36:39], v[124:139]
    v_lshlrev_b32 v248, 16, v247
    v_and_b32 v247, 0xffff0000, v247
    v_add_f32 v247, v247, v248
    v_mov_b32 v246, v247
    buffer_load_dwordx4 v4, s[4:7], s72 offen offset:1024 lds
    v_lshlrev_b32 v247, 16, v213
    v_and_b32 v248, 0xffff0000, v213
    v_lshlrev_b32 v249, 16, v221
    v_and_b32 v250, 0xffff0000, v221
    v_mul_f32 v247, v247, v249
    v_mul_f32 v248, v248, v250
    v_cvt_pk_bf16_f32 v247, v247, v248
    v_lshlrev_b32 v248, 16, v247
    v_and_b32 v247, 0xffff0000, v247
    v_add_f32 v247, v247, v248
    v_add_f32 v246, v246, v247
    s_waitcnt lgkmcnt(3)
    v_lshlrev_b32 v247, 16, v214
    v_and_b32 v248, 0xffff0000, v214
    v_lshlrev_b32 v249, 16, v222
    v_and_b32 v250, 0xffff0000, v222
    buffer_load_dwordx4 v5, s[4:7], s72 offen offset:2048 lds
    v_mul_f32 v247, v247, v249
    v_mul_f32 v248, v248, v250
    v_cvt_pk_bf16_f32 v247, v247, v248
    v_lshlrev_b32 v248, 16, v247
    v_and_b32 v247, 0xffff0000, v247
    v_add_f32 v247, v247, v248
    v_add_f32 v246, v246, v247
    buffer_load_dwordx4 v6, s[4:7], s72 offen offset:3072 lds
    s_xor_b32 s72, s93, 5
    s_mul_i32 s72, s72, 196608
    s_add_u32 m0, s67, 0x22000
    s_nop 0
    buffer_load_dwordx4 v7, s[8:11], s72 offen offset:0 lds
    buffer_load_dwordx4 v8, s[8:11], s72 offen offset:1024 lds
    s_waitcnt vmcnt(12)
    s_barrier
    ds_read_b128 a[48:51], v18 offset:49152
    ds_read_b64_tr_b16 v[96:97], v23 offset:24576
    ds_read_b64_tr_b16 v[98:99], v23 offset:25088
    s_xor_b32 s72, s93, 6
    s_mul_i32 s72, s72, 128
    s_add_u32 m0, s69, 0x0
    v_mfma_f32_32x32x16_bf16 v[108:123], v[80:83], a[40:43], v[108:123]
    buffer_load_dwordx4 v3, s[4:7], s72 offen offset:0 lds
    ds_read_b64_tr_b16 v[100:101], v24 offset:24576
    ds_read_b64_tr_b16 v[102:103], v24 offset:25088
    v_mfma_f32_32x32x16_bf16 v[124:139], v[84:87], a[40:43], v[124:139]
    buffer_load_dwordx4 v4, s[4:7], s72 offen offset:1024 lds
    ds_read_b128 a[52:55], v19 offset:49152
    ds_read_b64_tr_b16 v[104:105], v23 offset:26624
    ds_read_b64_tr_b16 v[106:107], v23 offset:27136
    v_mfma_f32_32x32x16_bf16 v[108:123], v[88:91], a[44:47], v[108:123]
    ds_read_b64_tr_b16 v[72:73], v24 offset:26624
    ds_read_b64_tr_b16 v[74:75], v24 offset:27136
    s_waitcnt lgkmcnt(10)
    v_mfma_f32_32x32x16_bf16 v[124:139], v[92:95], a[44:47], v[124:139]
    buffer_load_dwordx4 v5, s[4:7], s72 offen offset:2048 lds
    ds_read_b128 a[56:59], v20 offset:49152
    ds_read_b64_tr_b16 v[76:77], v23 offset:28672
    ds_read_b64_tr_b16 v[78:79], v23 offset:29184
    s_waitcnt lgkmcnt(10)
    v_mfma_f32_32x32x16_bf16 v[108:123], v[96:99], a[48:51], v[108:123]
    ds_read_b64_tr_b16 v[80:81], v24 offset:28672
    ds_read_b64_tr_b16 v[82:83], v24 offset:29184
    s_waitcnt lgkmcnt(10)
    v_mfma_f32_32x32x16_bf16 v[124:139], v[100:103], a[48:51], v[124:139]
    buffer_load_dwordx4 v6, s[4:7], s72 offen offset:3072 lds
    ds_read_b128 a[60:63], v21 offset:49152
    ds_read_b64_tr_b16 v[84:85], v23 offset:30720
    ds_read_b64_tr_b16 v[86:87], v23 offset:31232
    s_waitcnt lgkmcnt(8)
    v_mfma_f32_32x32x16_bf16 v[108:123], v[104:107], a[52:55], v[108:123]
    ds_read_b32 v215, v22 offset:49152
    ds_read_b64_tr_b16 v[88:89], v24 offset:30720
    ds_read_b64_tr_b16 v[90:91], v24 offset:31232
    s_xor_b32 s72, s93, 6
    s_mul_i32 s72, s72, 196608
    s_add_u32 m0, s67, 0x24000
    v_mfma_f32_32x32x16_bf16 v[124:139], v[72:75], a[52:55], v[124:139]
    buffer_load_dwordx4 v7, s[8:11], s72 offen offset:0 lds
    buffer_load_dwordx4 v8, s[8:11], s72 offen offset:1024 lds
    s_waitcnt vmcnt(12)
    s_barrier
    v_add_u32 v18, 65536, v18
    v_add_u32 v19, 65536, v19
    v_add_u32 v20, 65536, v20
    v_add_u32 v21, 65536, v21
    v_add_u32 v22, 65536, v22
    ds_read_b128 a[64:67], v18 offset:0
    ds_read_b64_tr_b16 v[92:93], v23 offset:32768
    ds_read_b64_tr_b16 v[94:95], v23 offset:33280
    s_xor_b32 s72, s93, 7
    s_mul_i32 s72, s72, 128
    s_add_u32 m0, s69, 0x4000
    s_waitcnt lgkmcnt(3)
    v_mfma_f32_32x32x16_bf16 v[108:123], v[76:79], a[56:59], v[108:123]
    buffer_load_dwordx4 v3, s[4:7], s72 offen offset:0 lds
    ds_read_b64_tr_b16 v[96:97], v24 offset:32768
    ds_read_b64_tr_b16 v[98:99], v24 offset:33280
    v_mfma_f32_32x32x16_bf16 v[124:139], v[80:83], a[56:59], v[124:139]
    buffer_load_dwordx4 v4, s[4:7], s72 offen offset:1024 lds
    ds_read_b128 a[68:71], v19 offset:0
    ds_read_b64_tr_b16 v[100:101], v23 offset:34816
    ds_read_b64_tr_b16 v[102:103], v23 offset:35328
    v_mfma_f32_32x32x16_bf16 v[108:123], v[84:87], a[60:63], v[108:123]
    buffer_load_dwordx4 v5, s[4:7], s72 offen offset:2048 lds
    ds_read_b64_tr_b16 v[104:105], v24 offset:34816
    ds_read_b64_tr_b16 v[106:107], v24 offset:35328
    v_mfma_f32_32x32x16_bf16 v[124:139], v[88:91], a[60:63], v[124:139]
    ds_read_b128 a[72:75], v20 offset:0
    ds_read_b64_tr_b16 v[72:73], v23 offset:36864
    ds_read_b64_tr_b16 v[74:75], v23 offset:37376
    v_lshlrev_b32 v247, 16, v215
    v_and_b32 v248, 0xffff0000, v215
    v_lshlrev_b32 v249, 16, v223
    v_and_b32 v250, 0xffff0000, v223
    s_waitcnt lgkmcnt(10)
    v_mfma_f32_32x32x16_bf16 v[108:123], v[92:95], a[64:67], v[108:123]
    buffer_load_dwordx4 v6, s[4:7], s72 offen offset:3072 lds
    ds_read_b64_tr_b16 v[76:77], v24 offset:36864
    ds_read_b64_tr_b16 v[78:79], v24 offset:37376
    s_waitcnt lgkmcnt(10)
    v_mfma_f32_32x32x16_bf16 v[124:139], v[96:99], a[64:67], v[124:139]
    ds_read_b128 a[76:79], v21 offset:0
    ds_read_b64_tr_b16 v[80:81], v23 offset:38912
    ds_read_b64_tr_b16 v[82:83], v23 offset:39424
    v_mul_f32 v247, v247, v249
    v_mul_f32 v248, v248, v250
    v_cvt_pk_bf16_f32 v247, v247, v248
    s_xor_b32 s72, s93, 7
    s_mul_i32 s72, s72, 196608
    s_add_u32 m0, s67, 0x26000
    s_waitcnt lgkmcnt(8)
    v_mfma_f32_32x32x16_bf16 v[108:123], v[100:103], a[68:71], v[108:123]
    buffer_load_dwordx4 v7, s[8:11], s72 offen offset:0 lds
    ds_read_b32 v216, v22 offset:0
    ds_read_b64_tr_b16 v[84:85], v24 offset:38912
    ds_read_b64_tr_b16 v[86:87], v24 offset:39424
    v_mfma_f32_32x32x16_bf16 v[124:139], v[104:107], a[68:71], v[124:139]
    buffer_load_dwordx4 v8, s[8:11], s72 offen offset:1024 lds
    s_waitcnt vmcnt(12)
    s_barrier
    ds_read_b128 a[80:83], v18 offset:16384
    ds_read_b64_tr_b16 v[88:89], v23 offset:40960
    ds_read_b64_tr_b16 v[90:91], v23 offset:41472
    s_mul_i32 s72, s93, 176128
    s_add_u32 m0, s68, 0x18000
    s_waitcnt lgkmcnt(3)
    v_mfma_f32_32x32x16_bf16 v[108:123], v[72:75], a[72:75], v[108:123]
    buffer_load_dwordx4 v9, s[12:15], s72 offen offset:0 lds
    ds_read_b64_tr_b16 v[92:93], v24 offset:40960
    ds_read_b64_tr_b16 v[94:95], v24 offset:41472
    v_mfma_f32_32x32x16_bf16 v[124:139], v[76:79], a[72:75], v[124:139]
    ds_read_b128 a[84:87], v19 offset:16384
    ds_read_b64_tr_b16 v[96:97], v23 offset:43008
    ds_read_b64_tr_b16 v[98:99], v23 offset:43520
    v_lshlrev_b32 v248, 16, v247
    v_and_b32 v247, 0xffff0000, v247
    v_add_f32 v247, v247, v248
    v_add_f32 v246, v246, v247
    v_mfma_f32_32x32x16_bf16 v[108:123], v[80:83], a[76:79], v[108:123]
    buffer_load_dwordx4 v10, s[12:15], s72 offen offset:1024 lds
    ds_read_b64_tr_b16 v[100:101], v24 offset:43008
    ds_read_b64_tr_b16 v[102:103], v24 offset:43520
    v_mfma_f32_32x32x16_bf16 v[124:139], v[84:87], a[76:79], v[124:139]
    ds_read_b128 a[88:91], v20 offset:16384
    ds_read_b64_tr_b16 v[104:105], v23 offset:45056
    ds_read_b64_tr_b16 v[106:107], v23 offset:45568
    v_lshlrev_b32 v247, 16, v216
    v_and_b32 v248, 0xffff0000, v216
    v_lshlrev_b32 v249, 16, v224
    v_and_b32 v250, 0xffff0000, v224
    s_waitcnt lgkmcnt(10)
    v_mfma_f32_32x32x16_bf16 v[108:123], v[88:91], a[80:83], v[108:123]
    ds_read_b64_tr_b16 v[72:73], v24 offset:45056
    ds_read_b64_tr_b16 v[74:75], v24 offset:45568
    v_mul_f32 v247, v247, v249
    v_mul_f32 v248, v248, v250
    v_cvt_pk_bf16_f32 v247, v247, v248
    s_waitcnt lgkmcnt(7)
    v_mfma_f32_32x32x16_bf16 v[124:139], v[92:95], a[80:83], v[124:139]
    buffer_load_dwordx4 v11, s[12:15], s72 offen offset:2048 lds
    ds_read_b128 a[92:95], v21 offset:16384
    ds_read_b64_tr_b16 v[76:77], v23 offset:47104
    ds_read_b64_tr_b16 v[78:79], v23 offset:47616
    v_mfma_f32_32x32x16_bf16 v[108:123], v[96:99], a[84:87], v[108:123]
    ds_read_b32 v217, v22 offset:16384
    ds_read_b64_tr_b16 v[80:81], v24 offset:47104
    ds_read_b64_tr_b16 v[82:83], v24 offset:47616
    v_lshlrev_b32 v248, 16, v247
    v_and_b32 v247, 0xffff0000, v247
    v_add_f32 v247, v247, v248
    v_add_f32 v246, v246, v247
    s_xor_b32 s72, s93, 1
    s_mul_i32 s72, s72, 176128
    s_add_u32 m0, s68, 0x1b000
    s_waitcnt lgkmcnt(8)
    v_mfma_f32_32x32x16_bf16 v[124:139], v[100:103], a[84:87], v[124:139]
    buffer_load_dwordx4 v9, s[12:15], s72 offen offset:0 lds
    buffer_load_dwordx4 v10, s[12:15], s72 offen offset:1024 lds
    s_waitcnt vmcnt(11)
    s_barrier
    v_subrev_u32 v18, 65536, v18
    v_subrev_u32 v19, 65536, v19
    v_subrev_u32 v20, 65536, v20
    v_subrev_u32 v21, 65536, v21
    v_subrev_u32 v22, 65536, v22
    ds_read_b128 a[96:99], v18 offset:0
    ds_read_b64_tr_b16 v[84:85], v23 offset:49152
    ds_read_b64_tr_b16 v[86:87], v23 offset:49664
    v_mfma_f32_32x32x16_bf16 v[108:123], v[104:107], a[88:91], v[108:123]
    ds_read_b64_tr_b16 v[88:89], v24 offset:49152
    ds_read_b64_tr_b16 v[90:91], v24 offset:49664
    s_waitcnt lgkmcnt(5)
    v_lshlrev_b32 v247, 16, v217
    v_and_b32 v248, 0xffff0000, v217
    v_lshlrev_b32 v249, 16, v225
    v_and_b32 v250, 0xffff0000, v225
    v_mfma_f32_32x32x16_bf16 v[124:139], v[72:75], a[88:91], v[124:139]
    buffer_load_dwordx4 v11, s[12:15], s72 offen offset:2048 lds
    ds_read_b128 a[100:103], v19 offset:0
    ds_read_b64_tr_b16 v[92:93], v23 offset:51200
    ds_read_b64_tr_b16 v[94:95], v23 offset:51712
    v_mfma_f32_32x32x16_bf16 v[108:123], v[76:79], a[92:95], v[108:123]
    ds_read_b64_tr_b16 v[96:97], v24 offset:51200
    ds_read_b64_tr_b16 v[98:99], v24 offset:51712
    v_mul_f32 v247, v247, v249
    v_mul_f32 v248, v248, v250
    v_cvt_pk_bf16_f32 v247, v247, v248
    v_mfma_f32_32x32x16_bf16 v[124:139], v[80:83], a[92:95], v[124:139]
    ds_read_b128 a[104:107], v20 offset:0
    ds_read_b64_tr_b16 v[100:101], v23 offset:53248
    ds_read_b64_tr_b16 v[102:103], v23 offset:53760
    v_lshlrev_b32 v248, 16, v247
    v_and_b32 v247, 0xffff0000, v247
    v_add_f32 v247, v247, v248
    v_add_f32 v246, v246, v247
    s_xor_b32 s72, s93, 2
    s_mul_i32 s72, s72, 176128
    s_add_u32 m0, s68, 0x8000
    s_waitcnt lgkmcnt(8)
    v_mfma_f32_32x32x16_bf16 v[108:123], v[84:87], a[96:99], v[108:123]
    buffer_load_dwordx4 v9, s[12:15], s72 offen offset:0 lds
    ds_read_b64_tr_b16 v[104:105], v24 offset:53248
    ds_read_b64_tr_b16 v[106:107], v24 offset:53760
    v_mfma_f32_32x32x16_bf16 v[124:139], v[88:91], a[96:99], v[124:139]
    ds_read_b128 a[108:111], v21 offset:0
    ds_read_b64_tr_b16 v[72:73], v23 offset:55296
    ds_read_b64_tr_b16 v[74:75], v23 offset:55808
    s_waitcnt lgkmcnt(8)
    v_mfma_f32_32x32x16_bf16 v[108:123], v[92:95], a[100:103], v[108:123]
    ds_read_b32 v218, v22 offset:0
    ds_read_b64_tr_b16 v[76:77], v24 offset:55296
    ds_read_b64_tr_b16 v[78:79], v24 offset:55808
    v_mfma_f32_32x32x16_bf16 v[124:139], v[96:99], a[100:103], v[124:139]
    buffer_load_dwordx4 v10, s[12:15], s72 offen offset:1024 lds
    buffer_load_dwordx4 v11, s[12:15], s72 offen offset:2048 lds
    s_waitcnt vmcnt(9)
    s_barrier
    ds_read_b128 a[112:115], v18 offset:16384
    ds_read_b64_tr_b16 v[80:81], v23 offset:57344
    ds_read_b64_tr_b16 v[82:83], v23 offset:57856
    s_waitcnt lgkmcnt(3)
    v_mfma_f32_32x32x16_bf16 v[108:123], v[100:103], a[104:107], v[108:123]
    ds_read_b64_tr_b16 v[84:85], v24 offset:57344
    ds_read_b64_tr_b16 v[86:87], v24 offset:57856
    v_lshlrev_b32 v247, 16, v218
    v_and_b32 v248, 0xffff0000, v218
    v_lshlrev_b32 v249, 16, v226
    v_and_b32 v250, 0xffff0000, v226
    v_mfma_f32_32x32x16_bf16 v[124:139], v[104:107], a[104:107], v[124:139]
    ds_read_b128 a[116:119], v19 offset:16384
    ds_read_b64_tr_b16 v[88:89], v23 offset:59392
    ds_read_b64_tr_b16 v[90:91], v23 offset:59904
    v_mul_f32 v247, v247, v249
    v_mul_f32 v248, v248, v250
    v_cvt_pk_bf16_f32 v247, v247, v248
    v_mfma_f32_32x32x16_bf16 v[108:123], v[72:75], a[108:111], v[108:123]
    ds_read_b64_tr_b16 v[92:93], v24 offset:59392
    ds_read_b64_tr_b16 v[94:95], v24 offset:59904
    v_lshlrev_b32 v248, 16, v247
    v_and_b32 v247, 0xffff0000, v247
    v_add_f32 v247, v247, v248
    v_add_f32 v246, v246, v247
    v_mfma_f32_32x32x16_bf16 v[124:139], v[76:79], a[108:111], v[124:139]
    ds_read_b128 a[120:123], v20 offset:16384
    ds_read_b64_tr_b16 v[96:97], v23 offset:61440
    ds_read_b64_tr_b16 v[98:99], v23 offset:61952
    s_waitcnt lgkmcnt(10)
    v_mfma_f32_32x32x16_bf16 v[108:123], v[80:83], a[112:115], v[108:123]
    ds_read_b64_tr_b16 v[100:101], v24 offset:61440
    ds_read_b64_tr_b16 v[102:103], v24 offset:61952
    s_waitcnt lgkmcnt(10)
    v_mfma_f32_32x32x16_bf16 v[124:139], v[84:87], a[112:115], v[124:139]
    ds_read_b128 a[124:127], v21 offset:16384
    ds_read_b64_tr_b16 v[104:105], v23 offset:63488
    ds_read_b64_tr_b16 v[106:107], v23 offset:64000
    s_waitcnt lgkmcnt(10)
    v_mfma_f32_32x32x16_bf16 v[108:123], v[88:91], a[116:119], v[108:123]
    ds_read_b32 v219, v22 offset:16384
    ds_read_b64_tr_b16 v[72:73], v24 offset:63488
    ds_read_b64_tr_b16 v[74:75], v24 offset:64000
    s_waitcnt lgkmcnt(11)
    v_mfma_f32_32x32x16_bf16 v[124:139], v[92:95], a[116:119], v[124:139]
    s_xor_b32 s72, s93, 3
    s_mul_i32 s72, s72, 176128
    s_add_u32 m0, s68, 0xb000
    s_nop 0
    buffer_load_dwordx4 v9, s[12:15], s72 offen offset:0 lds
    buffer_load_dwordx4 v10, s[12:15], s72 offen offset:1024 lds
    buffer_load_dwordx4 v11, s[12:15], s72 offen offset:2048 lds
    s_waitcnt lgkmcnt(0)
    v_lshlrev_b32 v247, 16, v219
    v_and_b32 v248, 0xffff0000, v219
    v_lshlrev_b32 v249, 16, v227
    v_and_b32 v250, 0xffff0000, v227
    v_mul_f32 v247, v247, v249
    v_mul_f32 v248, v248, v250
    v_cvt_pk_bf16_f32 v247, v247, v248
    v_lshlrev_b32 v248, 16, v247
    v_and_b32 v247, 0xffff0000, v247
    v_add_f32 v247, v247, v248
    v_add_f32 v246, v246, v247
    s_waitcnt vmcnt(9)
    s_barrier
    ds_read_b64_tr_b16 v[76:77], v26 offset:0
    ds_read_b64_tr_b16 v[78:79], v26 offset:768
    s_xor_b32 s72, s93, 4
    s_mul_i32 s72, s72, 176128
    s_add_u32 m0, s68, 0xe000
    v_mfma_f32_32x32x16_bf16 v[108:123], v[96:99], a[120:123], v[108:123]
    buffer_load_dwordx4 v9, s[12:15], s72 offen offset:0 lds
    s_load_dword s32, s[36:37], 0x0
    ds_read_b64_tr_b16 v[80:81], v26 offset:64
    ds_read_b64_tr_b16 v[82:83], v26 offset:832
    v_mfma_f32_32x32x16_bf16 v[124:139], v[100:103], a[120:123], v[124:139]
    ds_read_b64_tr_b16 v[84:85], v26 offset:128
    ds_read_b64_tr_b16 v[86:87], v26 offset:896
    v_add_f32_dpp v246, v246, v246 row_ror:8 row_mask:0xf bank_mask:0xf
    s_nop 1
    v_add_f32_dpp v246, v246, v246 row_ror:4 row_mask:0xf bank_mask:0xf
    v_mfma_f32_32x32x16_bf16 v[108:123], v[104:107], a[124:127], v[108:123]
    buffer_load_dwordx4 v10, s[12:15], s72 offen offset:1024 lds
    ds_read_b64_tr_b16 v[88:89], v26 offset:3072
    ds_read_b64_tr_b16 v[90:91], v26 offset:3840
    v_mfma_f32_32x32x16_bf16 v[124:139], v[72:75], a[124:127], v[124:139]
    ds_read_b64_tr_b16 v[92:93], v26 offset:3136
    ds_read_b64_tr_b16 v[94:95], v26 offset:3904
    v_add_f32_dpp v246, v246, v246 row_ror:2 row_mask:0xf bank_mask:0xf
    s_nop 1
    v_add_f32_dpp v246, v246, v246 row_ror:1 row_mask:0xf bank_mask:0xf
    s_branch L_p1e
.p2align 12
L_p1v:
    s_cbranch_execz Lt_back
    s_xor_b32 s72, s93, 2
    s_mul_i32 s72, s72, 196608
    s_add_u32 m0, s67, 0x1c000
    s_waitcnt lgkmcnt(10)
    v_mfma_f32_32x32x16_bf16 v[108:123], a[0:3], v[72:75], 0
    buffer_load_dwordx4 v7, s[8:11], s72 offen offset:0 lds
    ds_read_b64_tr_b16 v[92:93], v24 offset:4096
    ds_read_b64_tr_b16 v[94:95], v24 offset:4608
    s_waitcnt lgkmcnt(10)
    v_mfma_f32_32x32x16_bf16 v[124:139], a[0:3], v[76:79], 0
    buffer_load_dwordx4 v8, s[8:11], s72 offen offset:1024 lds
    ds_read_b128 a[12:15], v21 offset:0
    ds_read_b64_tr_b16 v[96:97], v23 offset:6144
    ds_read_b64_tr_b16 v[98:99], v23 offset:6656
    s_waitcnt lgkmcnt(5)
    v_mfma_f32_32x32x16_bf16 v[108:123], a[4:7], v[80:83], v[108:123]
    ds_read_b32 v212, v22 offset:0
    ds_read_b64_tr_b16 v[100:101], v24 offset:6144
    ds_read_b64_tr_b16 v[102:103], v24 offset:6656
    s_add_u32 s97, s73, 1
    s_lshl_b32 s75, s97, 16
    s_add_u32 s75, s75, s92
    s_cmp_ge_u32 s97, 8
    s_cselect_b32 s75, s75, 0x1000000
    v_mfma_f32_32x32x16_bf16 v[124:139], a[4:7], v[84:87], v[124:139]
    v_lshlrev_b32 v234, 2, v229
    v_sub_u32 v240, v230, v234
    v_mov_b32 v241, 0xf149f2ca
    v_cmp_le_i32 s[50:51], 0, v240
    s_xor_b32 s72, s93, 3
    s_mul_i32 s72, s72, 128
    s_add_u32 m0, s69, 0xc000
    s_nop 0
    buffer_load_dwordx4 v3, s[4:7], s72 offen offset:0 lds
    v_cmp_le_i32 s[52:53], 1, v240
    v_cmp_le_i32 s[54:55], 2, v240
    v_cmp_le_i32 s[56:57], 3, v240
    v_cndmask_b32 v40, v241, 0, s[50:51]
    v_cndmask_b32 v56, 0, v241, s[50:51]
    v_cndmask_b32 v41, v241, 0, s[52:53]
    v_cndmask_b32 v57, 0, v241, s[52:53]
    v_cndmask_b32 v42, v241, 0, s[54:55]
    v_cndmask_b32 v58, 0, v241, s[54:55]
    v_cndmask_b32 v43, v241, 0, s[56:57]
    v_cndmask_b32 v59, 0, v241, s[56:57]
    v_cmp_le_i32 s[50:51], 8, v240
    v_cmp_le_i32 s[52:53], 9, v240
    v_cmp_le_i32 s[54:55], 10, v240
    v_cmp_le_i32 s[56:57], 11, v240
    v_cndmask_b32 v44, v241, 0, s[50:51]
    v_cndmask_b32 v60, 0, v241, s[50:51]
    v_cndmask_b32 v45, v241, 0, s[52:53]
    v_cndmask_b32 v61, 0, v241, s[52:53]
    v_cndmask_b32 v46, v241, 0, s[54:55]
    buffer_load_dwordx4 v4, s[4:7], s72 offen offset:1024 lds
    v_cndmask_b32 v62, 0, v241, s[54:55]
    v_cndmask_b32 v47, v241, 0, s[56:57]
    v_cndmask_b32 v63, 0, v241, s[56:57]
    v_cmp_le_i32 s[50:51], 16, v240
    v_cmp_le_i32 s[52:53], 17, v240
    v_cmp_le_i32 s[54:55], 18, v240
    v_cmp_le_i32 s[56:57], 19, v240
    v_cndmask_b32 v48, v241, 0, s[50:51]
    v_cndmask_b32 v64, 0, v241, s[50:51]
    v_cndmask_b32 v49, v241, 0, s[52:53]
    v_cndmask_b32 v65, 0, v241, s[52:53]
    v_cndmask_b32 v50, v241, 0, s[54:55]
    v_cndmask_b32 v66, 0, v241, s[54:55]
    v_cndmask_b32 v51, v241, 0, s[56:57]
    v_cndmask_b32 v67, 0, v241, s[56:57]
    v_cmp_le_i32 s[50:51], 24, v240
    buffer_load_dwordx4 v5, s[4:7], s72 offen offset:2048 lds
    v_cmp_le_i32 s[52:53], 25, v240
    v_cmp_le_i32 s[54:55], 26, v240
    v_cmp_le_i32 s[56:57], 27, v240
    v_cndmask_b32 v52, v241, 0, s[50:51]
    v_cndmask_b32 v68, 0, v241, s[50:51]
    v_cndmask_b32 v53, v241, 0, s[52:53]
    v_cndmask_b32 v69, 0, v241, s[52:53]
    v_cndmask_b32 v54, v241, 0, s[54:55]
    v_cndmask_b32 v70, 0, v241, s[54:55]
    v_cndmask_b32 v55, v241, 0, s[56:57]
    v_cndmask_b32 v71, 0, v241, s[56:57]
    s_mul_i32 s73, s64, 6
    v_add_u32 v242, s73, v232
    v_and_b32 v234, 1, v232
    v_add3_u32 v243, v234, 4, s73
    s_lshl_b32 s92, s65, 3
    buffer_load_dwordx4 v6, s[4:7], s72 offen offset:3072 lds
    v_mov_b32 v235, 0x3f803f80
    v_and_b32 v234, 11, v228
    v_cmp_eq_u32 vcc, 0, v234
    s_nop 1
    v_cndmask_b32 v235, 0, v235, vcc
    v_add_u32 v234, s92, v242
    v_cmp_le_u32 vcc, 16, v234
    s_nop 1
    v_cndmask_b32 v244, 0, v235, vcc
    v_add_u32 v234, s92, v243
    v_cmp_le_u32 vcc, 16, v234
    s_nop 1
    v_cndmask_b32 v245, 0, v235, vcc
    v_and_b32 v234, 15, v228
    v_lshlrev_b32 v234, 4, v234
    v_add_u32 v234, 1024, v234
    v_mul_u32_u24 v242, 1280, v242
    v_add_u32 v242, v242, v234
    v_mul_u32_u24 v243, 1280, v243
    v_add_u32 v243, v243, v234
    s_xor_b32 s72, s93, 3
    s_mul_i32 s72, s72, 196608
    s_add_u32 m0, s67, 0x1e000
    s_nop 0
    buffer_load_dwordx4 v7, s[8:11], s72 offen offset:0 lds
    s_waitcnt vmcnt(12)
    s_barrier
    ds_read_b128 a[16:19], v18 offset:16384
    ds_read_b64_tr_b16 v[104:105], v23 offset:8192
    ds_read_b64_tr_b16 v[106:107], v23 offset:8704
    v_mfma_f32_32x32x16_bf16 v[108:123], a[8:11], v[88:91], v[108:123]
    buffer_load_dwordx4 v8, s[8:11], s72 offen offset:1024 lds
    ds_read_b64_tr_b16 v[72:73], v24 offset:8192
    ds_read_b64_tr_b16 v[74:75], v24 offset:8704
    s_xor_b32 s72, s93, 4
    s_mul_i32 s72, s72, 128
    s_add_u32 m0, s69, 0x10000
    s_waitcnt lgkmcnt(5)
    v_mfma_f32_32x32x16_bf16 v[124:139], a[8:11], v[92:95], v[124:139]
    buffer_load_dwordx4 v3, s[4:7], s72 offen offset:0 lds
    ds_read_b128 a[20:23], v19 offset:16384
    ds_read_b64_tr_b16 v[76:77], v23 offset:10240
    ds_read_b64_tr_b16 v[78:79], v23 offset:10752
    v_mfma_f32_32x32x16_bf16 v[108:123], a[12:15], v[96:99], v[108:123]
    ds_read_b64_tr_b16 v[80:81], v24 offset:10240
    ds_read_b64_tr_b16 v[82:83], v24 offset:10752
    v_mfma_f32_32x32x16_bf16 v[124:139], a[12:15], v[100:103], v[124:139]
    buffer_load_dwordx4 v4, s[4:7], s72 offen offset:1024 lds
    ds_read_b128 a[24:27], v20 offset:16384
    ds_read_b64_tr_b16 v[84:85], v23 offset:12288
    ds_read_b64_tr_b16 v[86:87], v23 offset:12800
    s_waitcnt lgkmcnt(8)
    v_mfma_f32_32x32x16_bf16 v[108:123], a[16:19], v[104:107], v[108:123]
    ds_read_b64_tr_b16 v[88:89], v24 offset:12288
    ds_read_b64_tr_b16 v[90:91], v24 offset:12800
    v_mfma_f32_32x32x16_bf16 v[124:139], a[16:19], v[72:75], v[124:139]
    buffer_load_dwordx4 v5, s[4:7], s72 offen offset:2048 lds
    ds_read_b128 a[28:31], v21 offset:16384
    ds_read_b64_tr_b16 v[92:93], v23 offset:14336
    ds_read_b64_tr_b16 v[94:95], v23 offset:14848
    s_waitcnt lgkmcnt(8)
    v_mfma_f32_32x32x16_bf16 v[108:123], a[20:23], v[76:79], v[108:123]
    ds_read_b32 v213, v22 offset:16384
    ds_read_b64_tr_b16 v[96:97], v24 offset:14336
    ds_read_b64_tr_b16 v[98:99], v24 offset:14848
    v_mfma_f32_32x32x16_bf16 v[124:139], a[20:23], v[80:83], v[124:139]
    buffer_load_dwordx4 v6, s[4:7], s72 offen offset:3072 lds
    s_xor_b32 s72, s93, 4
    s_mul_i32 s72, s72, 196608
    s_add_u32 m0, s67, 0x20000
    s_nop 0
    buffer_load_dwordx4 v7, s[8:11], s72 offen offset:0 lds
    buffer_load_dwordx4 v8, s[8:11], s72 offen offset:1024 lds
    s_waitcnt vmcnt(12)
    s_barrier
    s_cmp_eq_u32 s94, 0
    s_cbranch_scc1 L_nogateV
    s_atomic_add s86, s[36:37], 0x0
L_nogateV:
    ds_read_b128 a[32:35], v18 offset:32768
    ds_read_b64_tr_b16 v[100:101], v23 offset:16384
    ds_read_b64_tr_b16 v[102:103], v23 offset:16896
    s_waitcnt lgkmcnt(3)
    v_mfma_f32_32x32x16_bf16 v[108:123], a[24:27], v[84:87], v[108:123]
    ds_read2_b32 v[220:221], v220 offset0:0 offset1:32
    ds_read_b64_tr_b16 v[104:105], v24 offset:16384
    ds_read_b64_tr_b16 v[106:107], v24 offset:16896
    v_mfma_f32_32x32x16_bf16 v[124:139], a[24:27], v[88:91], v[124:139]
    ds_read_b128 a[36:39], v19 offset:32768
    ds_read_b64_tr_b16 v[72:73], v23 offset:18432
    ds_read_b64_tr_b16 v[74:75], v23 offset:18944
    v_mfma_f32_32x32x16_bf16 v[108:123], a[28:31], v[92:95], v[108:123]
    ds_read2_b32 v[222:223], v222 offset0:0 offset1:32
    ds_read_b64_tr_b16 v[76:77], v24 offset:18432
    ds_read_b64_tr_b16 v[78:79], v24 offset:18944
    v_mfma_f32_32x32x16_bf16 v[124:139], a[28:31], v[96:99], v[124:139]
    ds_read_b128 a[40:43], v20 offset:32768
    ds_read_b64_tr_b16 v[80:81], v23 offset:20480
    ds_read_b64_tr_b16 v[82:83], v23 offset:20992
    v_lshlrev_b32 v247, 16, v212
    v_and_b32 v248, 0xffff0000, v212
    s_waitcnt lgkmcnt(11)
    v_lshlrev_b32 v249, 16, v220
    v_and_b32 v250, 0xffff0000, v220
    v_mfma_f32_32x32x16_bf16 v[108:123], a[32:35], v[100:103], v[108:123]
    ds_read2_b32 v[224:225], v224 offset0:0 offset1:32
    ds_read_b64_tr_b16 v[84:85], v24 offset:20480
    ds_read_b64_tr_b16 v[86:87], v24 offset:20992
    v_mul_f32 v247, v247, v249
    v_mul_f32 v248, v248, v250
    v_cvt_pk_bf16_f32 v247, v247, v248
    s_xor_b32 s72, s93, 5
    s_mul_i32 s72, s72, 128
    s_add_u32 m0, s69, 0x14000
    s_waitcnt lgkmcnt(9)
    v_mfma_f32_32x32x16_bf16 v[124:139], a[32:35], v[104:107], v[124:139]
    buffer_load_dwordx4 v3, s[4:7], s72 offen offset:0 lds
    ds_read_b128 a[44:47], v21 offset:32768
    ds_read_b64_tr_b16 v[88:89], v23 offset:22528
    ds_read_b64_tr_b16 v[90:91], v23 offset:23040
    v_mfma_f32_32x32x16_bf16 v[108:123], a[36:39], v[72:75], v[108:123]
    ds_read_b32 v214, v22 offset:32768
    ds_read2_b32 v[226:227], v226 offset0:0 offset1:32
    ds_read_b64_tr_b16 v[92:93], v24 offset:22528
    ds_read_b64_tr_b16 v[94:95], v24 offset:23040
    s_waitcnt lgkmcnt(10)
    v_mfma_f32_32x32x16_bf16 v[124:139], a[36:39], v[76:79], v[124:139]
    v_lshlrev_b32 v248, 16, v247
    v_and_b32 v247, 0xffff0000, v247
    v_add_f32 v247, v247, v248
    v_mov_b32 v246, v247
    buffer_load_dwordx4 v4, s[4:7], s72 offen offset:1024 lds
    v_lshlrev_b32 v247, 16, v213
    v_and_b32 v248, 0xffff0000, v213
    v_lshlrev_b32 v249, 16, v221
    v_and_b32 v250, 0xffff0000, v221
    v_mul_f32 v247, v247, v249
    v_mul_f32 v248, v248, v250
    v_cvt_pk_bf16_f32 v247, v247, v248
    v_lshlrev_b32 v248, 16, v247
    v_and_b32 v247, 0xffff0000, v247
    v_add_f32 v247, v247, v248
    v_add_f32 v246, v246, v247
    s_waitcnt lgkmcnt(3)
    v_lshlrev_b32 v247, 16, v214
    v_and_b32 v248, 0xffff0000, v214
    v_lshlrev_b32 v249, 16, v222
    v_and_b32 v250, 0xffff0000, v222
    buffer_load_dwordx4 v5, s[4:7], s72 offen offset:2048 lds
    v_mul_f32 v247, v247, v249
    v_mul_f32 v248, v248, v250
    v_cvt_pk_bf16_f32 v247, v247, v248
    v_lshlrev_b32 v248, 16, v247
    v_and_b32 v247, 0xffff0000, v247
    v_add_f32 v247, v247, v248
    v_add_f32 v246, v246, v247
    buffer_load_dwordx4 v6, s[4:7], s72 offen offset:3072 lds
    s_xor_b32 s72, s93, 5
    s_mul_i32 s72, s72, 196608
    s_add_u32 m0, s67, 0x22000
    s_nop 0
    buffer_load_dwordx4 v7, s[8:11], s72 offen offset:0 lds
    buffer_load_dwordx4 v8, s[8:11], s72 offen offset:1024 lds
    s_waitcnt vmcnt(12)
    s_barrier
    ds_read_b128 a[48:51], v18 offset:49152
    ds_read_b64_tr_b16 v[96:97], v23 offset:24576
    ds_read_b64_tr_b16 v[98:99], v23 offset:25088
    s_xor_b32 s72, s93, 6
    s_mul_i32 s72, s72, 128
    s_add_u32 m0, s69, 0x0
    v_mfma_f32_32x32x16_bf16 v[108:123], a[40:43], v[80:83], v[108:123]
    buffer_load_dwordx4 v3, s[4:7], s72 offen offset:0 lds
    ds_read_b64_tr_b16 v[100:101], v24 offset:24576
    ds_read_b64_tr_b16 v[102:103], v24 offset:25088
    v_mfma_f32_32x32x16_bf16 v[124:139], a[40:43], v[84:87], v[124:139]
    buffer_load_dwordx4 v4, s[4:7], s72 offen offset:1024 lds
    ds_read_b128 a[52:55], v19 offset:49152
    ds_read_b64_tr_b16 v[104:105], v23 offset:26624
    ds_read_b64_tr_b16 v[106:107], v23 offset:27136
    v_mfma_f32_32x32x16_bf16 v[108:123], a[44:47], v[88:91], v[108:123]
    ds_read_b64_tr_b16 v[72:73], v24 offset:26624
    ds_read_b64_tr_b16 v[74:75], v24 offset:27136
    s_waitcnt lgkmcnt(10)
    v_mfma_f32_32x32x16_bf16 v[124:139], a[44:47], v[92:95], v[124:139]
    buffer_load_dwordx4 v5, s[4:7], s72 offen offset:2048 lds
    ds_read_b128 a[56:59], v20 offset:49152
    ds_read_b64_tr_b16 v[76:77], v23 offset:28672
    ds_read_b64_tr_b16 v[78:79], v23 offset:29184
    s_waitcnt lgkmcnt(10)
    v_mfma_f32_32x32x16_bf16 v[108:123], a[48:51], v[96:99], v[108:123]
    ds_read_b64_tr_b16 v[80:81], v24 offset:28672
    ds_read_b64_tr_b16 v[82:83], v24 offset:29184
    s_waitcnt lgkmcnt(10)
    v_mfma_f32_32x32x16_bf16 v[124:139], a[48:51], v[100:103], v[124:139]
    buffer_load_dwordx4 v6, s[4:7], s72 offen offset:3072 lds
    ds_read_b128 a[60:63], v21 offset:49152
    ds_read_b64_tr_b16 v[84:85], v23 offset:30720
    ds_read_b64_tr_b16 v[86:87], v23 offset:31232
    s_waitcnt lgkmcnt(8)
    v_mfma_f32_32x32x16_bf16 v[108:123], a[52:55], v[104:107], v[108:123]
    ds_read_b32 v215, v22 offset:49152
    ds_read_b64_tr_b16 v[88:89], v24 offset:30720
    ds_read_b64_tr_b16 v[90:91], v24 offset:31232
    s_xor_b32 s72, s93, 6
    s_mul_i32 s72, s72, 196608
    s_add_u32 m0, s67, 0x24000
    v_mfma_f32_32x32x16_bf16 v[124:139], a[52:55], v[72:75], v[124:139]
    buffer_load_dwordx4 v7, s[8:11], s72 offen offset:0 lds
    buffer_load_dwordx4 v8, s[8:11], s72 offen offset:1024 lds
    s_waitcnt vmcnt(12)
    s_barrier
    v_add_u32 v18, 65536, v18
    v_add_u32 v19, 65536, v19
    v_add_u32 v20, 65536, v20
    v_add_u32 v21, 65536, v21
    v_add_u32 v22, 65536, v22
    ds_read_b128 a[64:67], v18 offset:0
    ds_read_b64_tr_b16 v[92:93], v23 offset:32768
    ds_read_b64_tr_b16 v[94:95], v23 offset:33280
    s_xor_b32 s72, s93, 7
    s_mul_i32 s72, s72, 128
    s_add_u32 m0, s69, 0x4000
    s_waitcnt lgkmcnt(3)
    v_mfma_f32_32x32x16_bf16 v[108:123], a[56:59], v[76:79], v[108:123]
    buffer_load_dwordx4 v3, s[4:7], s72 offen offset:0 lds
    ds_read_b64_tr_b16 v[96:97], v24 offset:32768
    ds_read_b64_tr_b16 v[98:99], v24 offset:33280
    v_mfma_f32_32x32x16_bf16 v[124:139], a[56:59], v[80:83], v[124:139]
    buffer_load_dwordx4 v4, s[4:7], s72 offen offset:1024 lds
    ds_read_b128 a[68:71], v19 offset:0
    ds_read_b64_tr_b16 v[100:101], v23 offset:34816
    ds_read_b64_tr_b16 v[102:103], v23 offset:35328
    v_mfma_f32_32x32x16_bf16 v[108:123], a[60:63], v[84:87], v[108:123]
    buffer_load_dwordx4 v5, s[4:7], s72 offen offset:2048 lds
    ds_read_b64_tr_b16 v[104:105], v24 offset:34816
    ds_read_b64_tr_b16 v[106:107], v24 offset:35328
    v_mfma_f32_32x32x16_bf16 v[124:139], a[60:63], v[88:91], v[124:139]
    ds_read_b128 a[72:75], v20 offset:0
    ds_read_b64_tr_b16 v[72:73], v23 offset:36864
    ds_read_b64_tr_b16 v[74:75], v23 offset:37376
    v_lshlrev_b32 v247, 16, v215
    v_and_b32 v248, 0xffff0000, v215
    v_lshlrev_b32 v249, 16, v223
    v_and_b32 v250, 0xffff0000, v223
    s_waitcnt lgkmcnt(10)
    v_mfma_f32_32x32x16_bf16 v[108:123], a[64:67], v[92:95], v[108:123]
    buffer_load_dwordx4 v6, s[4:7], s72 offen offset:3072 lds
    ds_read_b64_tr_b16 v[76:77], v24 offset:36864
    ds_read_b64_tr_b16 v[78:79], v24 offset:37376
    s_waitcnt lgkmcnt(10)
    v_mfma_f32_32x32x16_bf16 v[124:139], a[64:67], v[96:99], v[124:139]
    ds_read_b128 a[76:79], v21 offset:0
    ds_read_b64_tr_b16 v[80:81], v23 offset:38912
    ds_read_b64_tr_b16 v[82:83], v23 offset:39424
    v_mul_f32 v247, v247, v249
    v_mul_f32 v248, v248, v250
    v_cvt_pk_bf16_f32 v247, v247, v248
    s_xor_b32 s72, s93, 7
    s_mul_i32 s72, s72, 196608
    s_add_u32 m0, s67, 0x26000
    s_waitcnt lgkmcnt(8)
    v_mfma_f32_32x32x16_bf16 v[108:123], a[68:71], v[100:103], v[108:123]
    buffer_load_dwordx4 v7, s[8:11], s72 offen offset:0 lds
    ds_read_b32 v216, v22 offset:0
    ds_read_b64_tr_b16 v[84:85], v24 offset:38912
    ds_read_b64_tr_b16 v[86:87], v24 offset:39424
    v_mfma_f32_32x32x16_bf16 v[124:139], a[68:71], v[104:107], v[124:139]
    buffer_load_dwordx4 v8, s[8:11], s72 offen offset:1024 lds
    s_waitcnt vmcnt(12)
    s_barrier
    ds_read_b128 a[80:83], v18 offset:16384
    ds_read_b64_tr_b16 v[88:89], v23 offset:40960
    ds_read_b64_tr_b16 v[90:91], v23 offset:41472
    s_mul_i32 s72, s93, 176128
    s_add_u32 m0, s68, 0x18000
    s_waitcnt lgkmcnt(3)
    v_mfma_f32_32x32x16_bf16 v[108:123], a[72:75], v[72:75], v[108:123]
    buffer_load_dwordx4 v9, s[12:15], s72 offen offset:0 lds
    ds_read_b64_tr_b16 v[92:93], v24 offset:40960
    ds_read_b64_tr_b16 v[94:95], v24 offset:41472
    v_mfma_f32_32x32x16_bf16 v[124:139], a[72:75], v[76:79], v[124:139]
    ds_read_b128 a[84:87], v19 offset:16384
    ds_read_b64_tr_b16 v[96:97], v23 offset:43008
    ds_read_b64_tr_b16 v[98:99], v23 offset:43520
    v_lshlrev_b32 v248, 16, v247
    v_and_b32 v247, 0xffff0000, v247
    v_add_f32 v247, v247, v248
    v_add_f32 v246, v246, v247
    v_mfma_f32_32x32x16_bf16 v[108:123], a[76:79], v[80:83], v[108:123]
    buffer_load_dwordx4 v10, s[12:15], s72 offen offset:1024 lds
    ds_read_b64_tr_b16 v[100:101], v24 offset:43008
    ds_read_b64_tr_b16 v[102:103], v24 offset:43520
    v_mfma_f32_32x32x16_bf16 v[124:139], a[76:79], v[84:87], v[124:139]
    ds_read_b128 a[88:91], v20 offset:16384
    ds_read_b64_tr_b16 v[104:105], v23 offset:45056
    ds_read_b64_tr_b16 v[106:107], v23 offset:45568
    v_lshlrev_b32 v247, 16, v216
    v_and_b32 v248, 0xffff0000, v216
    v_lshlrev_b32 v249, 16, v224
    v_and_b32 v250, 0xffff0000, v224
    s_waitcnt lgkmcnt(10)
    v_mfma_f32_32x32x16_bf16 v[108:123], a[80:83], v[88:91], v[108:123]
    ds_read_b64_tr_b16 v[72:73], v24 offset:45056
    ds_read_b64_tr_b16 v[74:75], v24 offset:45568
    v_mul_f32 v247, v247, v249
    v_mul_f32 v248, v248, v250
    v_cvt_pk_bf16_f32 v247, v247, v248
    s_waitcnt lgkmcnt(7)
    v_mfma_f32_32x32x16_bf16 v[124:139], a[80:83], v[92:95], v[124:139]
    buffer_load_dwordx4 v11, s[12:15], s72 offen offset:2048 lds
    ds_read_b128 a[92:95], v21 offset:16384
    ds_read_b64_tr_b16 v[76:77], v23 offset:47104
    ds_read_b64_tr_b16 v[78:79], v23 offset:47616
    v_mfma_f32_32x32x16_bf16 v[108:123], a[84:87], v[96:99], v[108:123]
    ds_read_b32 v217, v22 offset:16384
    ds_read_b64_tr_b16 v[80:81], v24 offset:47104
    ds_read_b64_tr_b16 v[82:83], v24 offset:47616
    v_lshlrev_b32 v248, 16, v247
    v_and_b32 v247, 0xffff0000, v247
    v_add_f32 v247, v247, v248
    v_add_f32 v246, v246, v247
    s_xor_b32 s72, s93, 1
    s_mul_i32 s72, s72, 176128
    s_add_u32 m0, s68, 0x1b000
    s_waitcnt lgkmcnt(8)
    v_mfma_f32_32x32x16_bf16 v[124:139], a[84:87], v[100:103], v[124:139]
    buffer_load_dwordx4 v9, s[12:15], s72 offen offset:0 lds
    buffer_load_dwordx4 v10, s[12:15], s72 offen offset:1024 lds
    s_waitcnt vmcnt(11)
    s_barrier
    v_subrev_u32 v18, 65536, v18
    v_subrev_u32 v19, 65536, v19
    v_subrev_u32 v20, 65536, v20
    v_subrev_u32 v21, 65536, v21
    v_subrev_u32 v22, 65536, v22
    ds_read_b128 a[96:99], v18 offset:0
    ds_read_b64_tr_b16 v[84:85], v23 offset:49152
    ds_read_b64_tr_b16 v[86:87], v23 offset:49664
    v_mfma_f32_32x32x16_bf16 v[108:123], a[88:91], v[104:107], v[108:123]
    ds_read_b64_tr_b16 v[88:89], v24 offset:49152
    ds_read_b64_tr_b16 v[90:91], v24 offset:49664
    s_waitcnt lgkmcnt(5)
    v_lshlrev_b32 v247, 16, v217
    v_and_b32 v248, 0xffff0000, v217
    v_lshlrev_b32 v249, 16, v225
    v_and_b32 v250, 0xffff0000, v225
    v_mfma_f32_32x32x16_bf16 v[124:139], a[88:91], v[72:75], v[124:139]
    buffer_load_dwordx4 v11, s[12:15], s72 offen offset:2048 lds
    ds_read_b128 a[100:103], v19 offset:0
    ds_read_b64_tr_b16 v[92:93], v23 offset:51200
    ds_read_b64_tr_b16 v[94:95], v23 offset:51712
    v_mfma_f32_32x32x16_bf16 v[108:123], a[92:95], v[76:79], v[108:123]
    ds_read_b64_tr_b16 v[96:97], v24 offset:51200
    ds_read_b64_tr_b16 v[98:99], v24 offset:51712
    v_mul_f32 v247, v247, v249
    v_mul_f32 v248, v248, v250
    v_cvt_pk_bf16_f32 v247, v247, v248
    v_mfma_f32_32x32x16_bf16 v[124:139], a[92:95], v[80:83], v[124:139]
    ds_read_b128 a[104:107], v20 offset:0
    ds_read_b64_tr_b16 v[100:101], v23 offset:53248
    ds_read_b64_tr_b16 v[102:103], v23 offset:53760
    v_lshlrev_b32 v248, 16, v247
    v_and_b32 v247, 0xffff0000, v247
    v_add_f32 v247, v247, v248
    v_add_f32 v246, v246, v247
    s_xor_b32 s72, s93, 2
    s_mul_i32 s72, s72, 176128
    s_add_u32 m0, s68, 0x8000
    s_waitcnt lgkmcnt(8)
    v_mfma_f32_32x32x16_bf16 v[108:123], a[96:99], v[84:87], v[108:123]
    buffer_load_dwordx4 v9, s[12:15], s72 offen offset:0 lds
    ds_read_b64_tr_b16 v[104:105], v24 offset:53248
    ds_read_b64_tr_b16 v[106:107], v24 offset:53760
    v_mfma_f32_32x32x16_bf16 v[124:139], a[96:99], v[88:91], v[124:139]
    ds_read_b128 a[108:111], v21 offset:0
    ds_read_b64_tr_b16 v[72:73], v23 offset:55296
    ds_read_b64_tr_b16 v[74:75], v23 offset:55808
    s_waitcnt lgkmcnt(8)
    v_mfma_f32_32x32x16_bf16 v[108:123], a[100:103], v[92:95], v[108:123]
    ds_read_b32 v218, v22 offset:0
    ds_read_b64_tr_b16 v[76:77], v24 offset:55296
    ds_read_b64_tr_b16 v[78:79], v24 offset:55808
    v_mfma_f32_32x32x16_bf16 v[124:139], a[100:103], v[96:99], v[124:139]
    buffer_load_dwordx4 v10, s[12:15], s72 offen offset:1024 lds
    buffer_load_dwordx4 v11, s[12:15], s72 offen offset:2048 lds
    s_waitcnt vmcnt(9)
    s_barrier
    ds_read_b128 a[112:115], v18 offset:16384
    ds_read_b64_tr_b16 v[80:81], v23 offset:57344
    ds_read_b64_tr_b16 v[82:83], v23 offset:57856
    s_waitcnt lgkmcnt(3)
    v_mfma_f32_32x32x16_bf16 v[108:123], a[104:107], v[100:103], v[108:123]
    ds_read_b64_tr_b16 v[84:85], v24 offset:57344
    ds_read_b64_tr_b16 v[86:87], v24 offset:57856
    v_lshlrev_b32 v247, 16, v218
    v_and_b32 v248, 0xffff0000, v218
    v_lshlrev_b32 v249, 16, v226
    v_and_b32 v250, 0xffff0000, v226
    v_mfma_f32_32x32x16_bf16 v[124:139], a[104:107], v[104:107], v[124:139]
    ds_read_b128 a[116:119], v19 offset:16384
    ds_read_b64_tr_b16 v[88:89], v23 offset:59392
    ds_read_b64_tr_b16 v[90:91], v23 offset:59904
    v_mul_f32 v247, v247, v249
    v_mul_f32 v248, v248, v250
    v_cvt_pk_bf16_f32 v247, v247, v248
    v_mfma_f32_32x32x16_bf16 v[108:123], a[108:111], v[72:75], v[108:123]
    ds_read_b64_tr_b16 v[92:93], v24 offset:59392
    ds_read_b64_tr_b16 v[94:95], v24 offset:59904
    v_lshlrev_b32 v248, 16, v247
    v_and_b32 v247, 0xffff0000, v247
    v_add_f32 v247, v247, v248
    v_add_f32 v246, v246, v247
    v_mfma_f32_32x32x16_bf16 v[124:139], a[108:111], v[76:79], v[124:139]
    ds_read_b128 a[120:123], v20 offset:16384
    ds_read_b64_tr_b16 v[96:97], v23 offset:61440
    ds_read_b64_tr_b16 v[98:99], v23 offset:61952
    s_waitcnt lgkmcnt(10)
    v_mfma_f32_32x32x16_bf16 v[108:123], a[112:115], v[80:83], v[108:123]
    ds_read_b64_tr_b16 v[100:101], v24 offset:61440
    ds_read_b64_tr_b16 v[102:103], v24 offset:61952
    s_waitcnt lgkmcnt(10)
    v_mfma_f32_32x32x16_bf16 v[124:139], a[112:115], v[84:87], v[124:139]
    ds_read_b128 a[124:127], v21 offset:16384
    ds_read_b64_tr_b16 v[104:105], v23 offset:63488
    ds_read_b64_tr_b16 v[106:107], v23 offset:64000
    s_waitcnt lgkmcnt(10)
    v_mfma_f32_32x32x16_bf16 v[108:123], a[116:119], v[88:91], v[108:123]
    ds_read_b32 v219, v22 offset:16384
    ds_read_b64_tr_b16 v[72:73], v24 offset:63488
    ds_read_b64_tr_b16 v[74:75], v24 offset:64000
    s_waitcnt lgkmcnt(11)
    v_mfma_f32_32x32x16_bf16 v[124:139], a[116:119], v[92:95], v[124:139]
    s_xor_b32 s72, s93, 3
    s_mul_i32 s72, s72, 176128
    s_add_u32 m0, s68, 0xb000
    s_nop 0
    buffer_load_dwordx4 v9, s[12:15], s72 offen offset:0 lds
    buffer_load_dwordx4 v10, s[12:15], s72 offen offset:1024 lds
    buffer_load_dwordx4 v11, s[12:15], s72 offen offset:2048 lds
    s_waitcnt lgkmcnt(0)
    v_lshlrev_b32 v247, 16, v219
    v_and_b32 v248, 0xffff0000, v219
    v_lshlrev_b32 v249, 16, v227
    v_and_b32 v250, 0xffff0000, v227
    v_mul_f32 v247, v247, v249
    v_mul_f32 v248, v248, v250
    v_cvt_pk_bf16_f32 v247, v247, v248
    v_lshlrev_b32 v248, 16, v247
    v_and_b32 v247, 0xffff0000, v247
    v_add_f32 v247, v247, v248
    v_add_f32 v246, v246, v247
    s_waitcnt vmcnt(9)
    s_barrier
    ds_read_b64_tr_b16 v[76:77], v26 offset:0
    ds_read_b64_tr_b16 v[78:79], v26 offset:768
    s_xor_b32 s72, s93, 4
    s_mul_i32 s72, s72, 176128
    s_add_u32 m0, s68, 0xe000
    v_mfma_f32_32x32x16_bf16 v[108:123], a[120:123], v[96:99], v[108:123]
    buffer_load_dwordx4 v9, s[12:15], s72 offen offset:0 lds
    s_load_dword s32, s[36:37], 0x0
    ds_read_b64_tr_b16 v[80:81], v26 offset:64
    ds_read_b64_tr_b16 v[82:83], v26 offset:832
    v_mfma_f32_32x32x16_bf16 v[124:139], a[120:123], v[100:103], v[124:139]
    ds_read_b64_tr_b16 v[84:85], v26 offset:128
    ds_read_b64_tr_b16 v[86:87], v26 offset:896
    v_add_f32_dpp v246, v246, v246 row_ror:8 row_mask:0xf bank_mask:0xf
    s_nop 1
    v_add_f32_dpp v246, v246, v246 row_ror:4 row_mask:0xf bank_mask:0xf
    v_mfma_f32_32x32x16_bf16 v[108:123], a[124:127], v[104:107], v[108:123]
    buffer_load_dwordx4 v10, s[12:15], s72 offen offset:1024 lds
    ds_read_b64_tr_b16 v[88:89], v26 offset:3072
    ds_read_b64_tr_b16 v[90:91], v26 offset:3840
    v_mfma_f32_32x32x16_bf16 v[124:139], a[124:127], v[72:75], v[124:139]
    ds_read_b64_tr_b16 v[92:93], v26 offset:3136
    ds_read_b64_tr_b16 v[94:95], v26 offset:3904
    v_add_f32_dpp v246, v246, v246 row_ror:2 row_mask:0xf bank_mask:0xf
    s_nop 1
    v_add_f32_dpp v246, v246, v246 row_ror:1 row_mask:0xf bank_mask:0xf
L_p1e:
    s_cbranch_execz Lt_back
    s_waitcnt lgkmcnt(8)
    v_mfma_f32_32x32x16_bf16 v[140:155], v[76:79], a[0:3], 0
    ds_read_b64_tr_b16 v[96:97], v26 offset:3200
    ds_read_b64_tr_b16 v[98:99], v26 offset:3968
    v_add_f32_dpp v246, v246, v246 row_bcast:15 row_mask:0xa bank_mask:0xf
    v_cvt_pk_bf16_f32 v246, v246, v246
    s_waitcnt lgkmcnt(8)
    v_mfma_f32_32x32x16_bf16 v[156:171], v[80:83], a[0:3], 0
    ds_read_b64_tr_b16 v[100:101], v26 offset:6144
    ds_read_b64_tr_b16 v[102:103], v26 offset:6912
    v_lshlrev_b32 v246, 16, v246
    v_mul_f32 v246, 0xbfb8aa3b, v246
    s_waitcnt lgkmcnt(8)
    v_mfma_f32_32x32x16_bf16 v[172:187], v[84:87], a[0:3], 0
    ds_read_b64_tr_b16 v[104:105], v26 offset:6208
    ds_read_b64_tr_b16 v[106:107], v26 offset:6976
    v_exp_f32 v246, v246
    s_nop 0
    v_add_f32 v246, 1.0, v246
    v_rcp_f32 v246, v246
    s_nop 0
    v_cvt_pk_bf16_f32 v246, v246, v246
    s_waitcnt lgkmcnt(8)
    v_mfma_f32_32x32x16_bf16 v[140:155], v[88:91], a[4:7], v[140:155]
    ds_read_b64_tr_b16 v[72:73], v26 offset:6272
    ds_read_b64_tr_b16 v[74:75], v26 offset:7040
Lt_0:
    s_cbranch_execz Lt_back
    v_lshlrev_b32 v248, 16, v246
    v_sub_f32 v249, 1.0, v248
    v_cvt_pk_bf16_f32 v249, v249, v249
    v_lshlrev_b32 v249, 16, v249
    s_waitcnt lgkmcnt(8)
    v_mfma_f32_32x32x16_bf16 v[156:171], v[92:95], a[4:7], v[156:171]
    buffer_load_dwordx4 v11, s[12:15], s72 offen offset:2048 lds
    ds_read_b64_tr_b16 v[76:77], v26 offset:9216
    ds_read_b64_tr_b16 v[78:79], v26 offset:9984
    v_cvt_pk_bf16_f32 v212, v108, v109
    v_cvt_pk_bf16_f32 v213, v110, v111
    v_cvt_pk_bf16_f32 v214, v112, v113
    s_lshl2_add_u32 s97, s2, s64
    s_sub_u32 s73, s97, 688
    s_mul_i32 s73, s73, 2048
    s_lshl_b32 s97, s97, 11
    s_cmp_lt_u32 s97, 1409024
    s_cselect_b64 s[60:61], s[16:17], s[20:21]
    s_cselect_b32 s73, s97, s73
    s_mov_b32 s62, 524288
    s_cselect_b32 s62, 1409024, s62
    s_mov_b32 s63, s7
    v_lshlrev_b32 v2, 1, v1
    s_waitcnt lgkmcnt(8)
    v_mfma_f32_32x32x16_bf16 v[172:187], v[96:99], a[4:7], v[172:187]
    buffer_load_dword v2, v2, s[60:63], s73 offen
    ds_read_b64_tr_b16 v[80:81], v26 offset:9280
    ds_read_b64_tr_b16 v[82:83], v26 offset:10048
    v_cvt_pk_bf16_f32 v215, v114, v115
    v_cvt_pk_bf16_f32 v216, v116, v117
    v_cvt_pk_bf16_f32 v217, v118, v119
    s_waitcnt lgkmcnt(8)
    v_mfma_f32_32x32x16_bf16 v[140:155], v[100:103], a[8:11], v[140:155]
    buffer_store_dwordx2 v[248:249], v38, s[24:27], s87 offen sc1
    ds_read_b64_tr_b16 v[84:85], v26 offset:9344
    ds_read_b64_tr_b16 v[86:87], v26 offset:10112
    v_cvt_pk_bf16_f32 v218, v120, v121
    v_cvt_pk_bf16_f32 v219, v122, v123
    v_cvt_pk_bf16_f32 v220, v124, v125
    s_waitcnt lgkmcnt(8)
    v_mfma_f32_32x32x16_bf16 v[156:171], v[104:107], a[8:11], v[156:171]
    buffer_store_dwordx4 v[212:215], v1, s[24:27], s77 offen offset:0 sc1
    s_waitcnt vmcnt(12)
    s_barrier
    ds_read_b64_tr_b16 v[88:89], v26 offset:12288
    ds_read_b64_tr_b16 v[90:91], v26 offset:13056
    v_cvt_pk_bf16_f32 v221, v126, v127
    v_cvt_pk_bf16_f32 v222, v128, v129
    v_cvt_pk_bf16_f32 v223, v130, v131
    s_waitcnt lgkmcnt(8)
    v_mfma_f32_32x32x16_bf16 v[172:187], v[72:75], a[8:11], v[172:187]
    ds_read_b64_tr_b16 v[92:93], v26 offset:12352
    ds_read_b64_tr_b16 v[94:95], v26 offset:13120
    v_cvt_pk_bf16_f32 v224, v132, v133
    v_cvt_pk_bf16_f32 v225, v134, v135
    v_cvt_pk_bf16_f32 v226, v136, v137
    v_cvt_pk_bf16_f32 v227, v138, v139
    s_waitcnt lgkmcnt(8)
    v_mfma_f32_32x32x16_bf16 v[140:155], v[76:79], a[12:15], v[140:155]
    ds_read_b64_tr_b16 v[96:97], v26 offset:12416
    ds_read_b64_tr_b16 v[98:99], v26 offset:13184
    v_dot2_f32_bf16 v252, v212, v212, 0
    v_dot2_f32_bf16 v253, v216, v216, 0
    v_dot2_f32_bf16 v254, v220, v220, 0
    s_waitcnt lgkmcnt(8)
    v_mfma_f32_32x32x16_bf16 v[156:171], v[80:83], a[12:15], v[156:171]
    ds_read_b64_tr_b16 v[100:101], v26 offset:15360
    ds_read_b64_tr_b16 v[102:103], v26 offset:16128
    v_dot2_f32_bf16 v255, v224, v224, 0
    v_dot2_f32_bf16 v252, v213, v213, v252
    v_dot2_f32_bf16 v253, v217, v217, v253
    v_dot2_f32_bf16 v254, v221, v221, v254
    s_waitcnt lgkmcnt(8)
    v_mfma_f32_32x32x16_bf16 v[172:187], v[84:87], a[12:15], v[172:187]
    buffer_store_dwordx4 v[216:219], v1, s[24:27], s77 offen offset:1024 sc1
    ds_read_b64_tr_b16 v[104:105], v26 offset:15424
    ds_read_b64_tr_b16 v[106:107], v26 offset:16192
    v_dot2_f32_bf16 v255, v225, v225, v255
    v_dot2_f32_bf16 v252, v214, v214, v252
    v_dot2_f32_bf16 v253, v218, v218, v253
    v_dot2_f32_bf16 v254, v222, v222, v254
    s_waitcnt lgkmcnt(8)
    v_mfma_f32_32x32x16_bf16 v[140:155], v[88:91], a[16:19], v[140:155]
    ds_read_b64_tr_b16 v[72:73], v26 offset:15488
    ds_read_b64_tr_b16 v[74:75], v26 offset:16256
    v_dot2_f32_bf16 v255, v226, v226, v255
    v_dot2_f32_bf16 v252, v215, v215, v252
    v_dot2_f32_bf16 v253, v219, v219, v253
    s_waitcnt lgkmcnt(8)
    v_mfma_f32_32x32x16_bf16 v[156:171], v[92:95], a[16:19], v[156:171]
    ds_read_b64_tr_b16 v[76:77], v26 offset:18432
    ds_read_b64_tr_b16 v[78:79], v26 offset:19200
    v_dot2_f32_bf16 v254, v223, v223, v254
    v_dot2_f32_bf16 v255, v227, v227, v255
    v_cmp_nle_f32 s[40:41], v252, s91
    s_waitcnt lgkmcnt(8)
    v_mfma_f32_32x32x16_bf16 v[172:187], v[96:99], a[16:19], v[172:187]
    ds_read_b64_tr_b16 v[80:81], v26 offset:18496
    ds_read_b64_tr_b16 v[82:83], v26 offset:19264
    v_cmp_nle_f32 s[42:43], v253, s91
    v_cmp_nle_f32 s[44:45], v254, s91
    v_cmp_nle_f32 s[46:47], v255, s91
    s_waitcnt lgkmcnt(8)
    v_mfma_f32_32x32x16_bf16 v[140:155], v[100:103], a[20:23], v[140:155]
    ds_read_b64_tr_b16 v[84:85], v26 offset:18560
    ds_read_b64_tr_b16 v[86:87], v26 offset:19328
    s_or_b64 s[40:41], s[40:41], s[42:43]
    s_or_b64 s[44:45], s[44:45], s[46:47]
    s_or_b64 s[40:41], s[40:41], s[44:45]
    s_cselect_b32 s91, 0x101, 1
    s_waitcnt lgkmcnt(8)
    v_mfma_f32_32x32x16_bf16 v[156:171], v[104:107], a[20:23], v[156:171]
    ds_read_b64_tr_b16 v[88:89], v26 offset:21504
    ds_read_b64_tr_b16 v[90:91], v26 offset:22272
    v_mov_b32 v108, v244
    v_mov_b32 v109, v244
    v_mov_b32 v110, v244
    v_mov_b32 v111, v244
    ds_write_b128 v242, v[108:111]
    v_mov_b32 v112, v245
    v_mov_b32 v113, v245
    v_mov_b32 v114, v245
    v_mov_b32 v115, v245
    ds_write_b128 v243, v[112:115]
    s_waitcnt lgkmcnt(10)
    v_mfma_f32_32x32x16_bf16 v[172:187], v[72:75], a[20:23], v[172:187]
    buffer_store_dwordx4 v[220:223], v1, s[24:27], s77 offen offset:2048 sc1
    ds_read_b64_tr_b16 v[92:93], v26 offset:21568
    ds_read_b64_tr_b16 v[94:95], v26 offset:22336
    s_waitcnt lgkmcnt(10)
    v_mfma_f32_32x32x16_bf16 v[140:155], v[76:79], a[24:27], v[140:155]
    buffer_store_dwordx4 v[224:227], v1, s[24:27], s77 offen offset:3072 sc1
    ds_read_b64_tr_b16 v[96:97], v26 offset:21632
    ds_read_b64_tr_b16 v[98:99], v26 offset:22400
    s_waitcnt lgkmcnt(10)
    v_mfma_f32_32x32x16_bf16 v[156:171], v[80:83], a[24:27], v[156:171]
    s_waitcnt vmcnt(12)
    s_barrier
    ds_read_b64_tr_b16 v[100:101], v25 offset:0
    ds_read_b64_tr_b16 v[102:103], v25 offset:768
    s_xor_b32 s72, s93, 5
    s_mul_i32 s72, s72, 176128
    s_add_u32 m0, s68, 0x11000
    s_waitcnt lgkmcnt(6)
    v_mfma_f32_32x32x16_bf16 v[172:187], v[84:87], a[24:27], v[172:187]
    buffer_load_dwordx4 v9, s[12:15], s72 offen offset:0 lds
    ds_read_b64_tr_b16 v[104:105], v25 offset:64
    ds_read_b64_tr_b16 v[106:107], v25 offset:832
    v_mfma_f32_32x32x16_bf16 v[140:155], v[88:91], a[28:31], v[140:155]
    ds_read_b64_tr_b16 v[72:73], v25 offset:128
    ds_read_b64_tr_b16 v[74:75], v25 offset:896
    s_waitcnt lgkmcnt(6)
    v_mfma_f32_32x32x16_bf16 v[156:171], v[92:95], a[28:31], v[156:171]
    buffer_load_dwordx4 v10, s[12:15], s72 offen offset:1024 lds
    ds_read_b64_tr_b16 v[76:77], v25 offset:3072
    ds_read_b64_tr_b16 v[78:79], v25 offset:3840
    v_mfma_f32_32x32x16_bf16 v[172:187], v[96:99], a[28:31], v[172:187]
    ds_read_b64_tr_b16 v[80:81], v25 offset:3136
    ds_read_b64_tr_b16 v[82:83], v25 offset:3904
    s_waitcnt lgkmcnt(8)
    v_mfma_f32_32x32x16_bf16 v[140:155], v[100:103], a[32:35], v[140:155]
    ds_read_b64_tr_b16 v[84:85], v25 offset:3200
    ds_read_b64_tr_b16 v[86:87], v25 offset:3968
    s_waitcnt lgkmcnt(8)
    v_mfma_f32_32x32x16_bf16 v[156:171], v[104:107], a[32:35], v[156:171]
    ds_read_b64_tr_b16 v[88:89], v25 offset:6144
    ds_read_b64_tr_b16 v[90:91], v25 offset:6912
    s_waitcnt lgkmcnt(8)
    v_mfma_f32_32x32x16_bf16 v[172:187], v[72:75], a[32:35], v[172:187]
    ds_read_b64_tr_b16 v[92:93], v25 offset:6208
    ds_read_b64_tr_b16 v[94:95], v25 offset:6976
    s_waitcnt lgkmcnt(8)
    v_mfma_f32_32x32x16_bf16 v[140:155], v[76:79], a[36:39], v[140:155]
    ds_read_b64_tr_b16 v[96:97], v25 offset:6272
    ds_read_b64_tr_b16 v[98:99], v25 offset:7040
    s_waitcnt lgkmcnt(8)
    v_mfma_f32_32x32x16_bf16 v[156:171], v[80:83], a[36:39], v[156:171]
    ds_read_b64_tr_b16 v[100:101], v25 offset:9216
    ds_read_b64_tr_b16 v[102:103], v25 offset:9984
    v_xor_b32 v18, 64, v32
    v_xor_b32 v19, 64, v33
    s_waitcnt lgkmcnt(8)
    v_mfma_f32_32x32x16_bf16 v[172:187], v[84:87], a[36:39], v[172:187]
    ds_read_b64_tr_b16 v[104:105], v25 offset:9280
    ds_read_b64_tr_b16 v[106:107], v25 offset:10048
    v_xor_b32 v20, 64, v34
    v_xor_b32 v21, 64, v35
    s_waitcnt lgkmcnt(8)
    v_mfma_f32_32x32x16_bf16 v[140:155], v[88:91], a[40:43], v[140:155]
    ds_read_b64_tr_b16 v[72:73], v25 offset:9344
    ds_read_b64_tr_b16 v[74:75], v25 offset:10112
    v_xor_b32 v22, 64, v36
    v_xor_b32 v23, 64, v37
    s_waitcnt lgkmcnt(8)
    v_mfma_f32_32x32x16_bf16 v[156:171], v[92:95], a[40:43], v[156:171]
    s_waitcnt vmcnt(11)
    s_barrier
    ds_read_b64_tr_b16 v[76:77], v25 offset:12288
    ds_read_b64_tr_b16 v[78:79], v25 offset:13056
    s_waitcnt lgkmcnt(6)
    v_mfma_f32_32x32x16_bf16 v[172:187], v[96:99], a[40:43], v[172:187]
    ds_read_b64_tr_b16 v[80:81], v25 offset:12352
    ds_read_b64_tr_b16 v[82:83], v25 offset:13120
    s_mul_i32 s97, s64, 4608
    s_sub_u32 s97, s97, s70
    s_add_u32 s97, s97, 135168
    v_add_u32 v228, s97, v1
    s_bitcmp1_b32 s66, 0
    s_cselect_b32 s97, 0x100, 0
    v_add_u32 v229, s97, v228
    ds_write_b128 v228, v[212:215] offset:0
    ds_write_b128 v229, v[216:219] offset:1024
    v_mfma_f32_32x32x16_bf16 v[140:155], v[100:103], a[44:47], v[140:155]
    ds_read_b64_tr_b16 v[84:85], v25 offset:12416
    ds_read_b64_tr_b16 v[86:87], v25 offset:13184
    v_lshrrev_b32 v8, 9, v1
    v_mul_u32_u24 v8, 7168, v8
    s_waitcnt lgkmcnt(8)
    v_mfma_f32_32x32x16_bf16 v[156:171], v[104:107], a[44:47], v[156:171]
    ds_read_b64_tr_b16 v[88:89], v25 offset:15360
    ds_read_b64_tr_b16 v[90:91], v25 offset:16128
    s_lshr_b32 s97, s96, 5
    v_subrev_u32 v8, s97, v8
    v_mfma_f32_32x32x16_bf16 v[172:187], v[72:75], a[44:47], v[172:187]
    ds_read_b64_tr_b16 v[92:93], v25 offset:15424
    ds_read_b64_tr_b16 v[94:95], v25 offset:16192
    v_add_u32 v24, v8, v32
    v_add_u32 v7, v8, v33
    s_waitcnt lgkmcnt(7)
    v_mfma_f32_32x32x16_bf16 v[140:155], v[76:79], a[48:51], v[140:155]
    buffer_load_dwordx4 v11, s[12:15], s72 offen offset:2048 lds
    ds_read_b64_tr_b16 v[96:97], v25 offset:15488
    ds_read_b64_tr_b16 v[98:99], v25 offset:16256
    v_mfma_f32_32x32x16_bf16 v[156:171], v[80:83], a[48:51], v[156:171]
    ds_read_b64_tr_b16 v[100:101], v25 offset:18432
    ds_read_b64_tr_b16 v[102:103], v25 offset:19200
    v_and_b32 v8, 0xf0, v1
    v_bfe_u32 v244, v1, 8, 1
    s_waitcnt lgkmcnt(8)
    v_mfma_f32_32x32x16_bf16 v[172:187], v[84:87], a[48:51], v[172:187]
    s_xor_b32 s72, s93, 6
    s_mul_i32 s72, s72, 176128
    s_add_u32 m0, s68, 0x1e000
    s_nop 0
    buffer_load_dwordx4 v9, s[12:15], s72 offen offset:0 lds
    ds_read_b64_tr_b16 v[104:105], v25 offset:18496
    ds_read_b64_tr_b16 v[106:107], v25 offset:19264
    s_waitcnt lgkmcnt(6)
    v_mfma_f32_32x32x16_bf16 v[140:155], v[88:91], a[52:55], v[140:155]
    ds_read_b64_tr_b16 v[72:73], v25 offset:18560
    ds_read_b64_tr_b16 v[74:75], v25 offset:19328
    v_lshl_or_b32 v8, v244, 10, v8
    v_lshrrev_b32 v244, 9, v1
    v_mfma_f32_32x32x16_bf16 v[156:171], v[92:95], a[52:55], v[156:171]
    buffer_load_dwordx4 v10, s[12:15], s72 offen offset:1024 lds
    ds_read_b64_tr_b16 v[76:77], v25 offset:21504
    ds_read_b64_tr_b16 v[78:79], v25 offset:22272
    s_waitcnt lgkmcnt(6)
    v_mfma_f32_32x32x16_bf16 v[172:187], v[96:99], a[52:55], v[172:187]
    ds_read_b64_tr_b16 v[80:81], v25 offset:21568
    ds_read_b64_tr_b16 v[82:83], v25 offset:22336
    v_lshl_or_b32 v8, v244, 8, v8
    v_mfma_f32_32x32x16_bf16 v[140:155], v[100:103], a[56:59], v[140:155]
    buffer_load_dwordx4 v11, s[12:15], s72 offen offset:2048 lds
    ds_read_b64_tr_b16 v[84:85], v25 offset:21632
    ds_read_b64_tr_b16 v[86:87], v25 offset:22400
    s_waitcnt lgkmcnt(7)
    v_mfma_f32_32x32x16_bf16 v[156:171], v[104:107], a[56:59], v[156:171]
    s_waitcnt vmcnt(12)
    s_barrier
    ds_read_b64_tr_b16 v[88:89], v25 offset:24576
    ds_read_b64_tr_b16 v[90:91], v25 offset:25344
    s_waitcnt lgkmcnt(6)
    v_mfma_f32_32x32x16_bf16 v[172:187], v[72:75], a[56:59], v[172:187]
    s_xor_b32 s72, s93, 7
    s_mul_i32 s72, s72, 176128
    s_add_u32 m0, s68, 0x21000
    s_nop 0
    buffer_load_dwordx4 v9, s[12:15], s72 offen offset:0 lds
    ds_read_b64_tr_b16 v[92:93], v25 offset:24640
    ds_read_b64_tr_b16 v[94:95], v25 offset:25408
    v_mfma_f32_32x32x16_bf16 v[140:155], v[76:79], a[60:63], v[140:155]
    ds_read_b64_tr_b16 v[96:97], v25 offset:24704
    ds_read_b64_tr_b16 v[98:99], v25 offset:25472
    s_waitcnt lgkmcnt(4)
    v_mfma_f32_32x32x16_bf16 v[156:171], v[80:83], a[60:63], v[156:171]
    buffer_load_dwordx4 v10, s[12:15], s72 offen offset:1024 lds
    ds_read_b64_tr_b16 v[100:101], v25 offset:27648
    ds_read_b64_tr_b16 v[102:103], v25 offset:28416
    v_mfma_f32_32x32x16_bf16 v[172:187], v[84:87], a[60:63], v[172:187]
    ds_read_b64_tr_b16 v[104:105], v25 offset:27712
    ds_read_b64_tr_b16 v[106:107], v25 offset:28480
    v_mfma_f32_32x32x16_bf16 v[140:155], v[88:91], a[64:67], v[140:155]
    buffer_load_dwordx4 v11, s[12:15], s72 offen offset:2048 lds
    ds_read_b64_tr_b16 v[72:73], v25 offset:27776
    ds_read_b64_tr_b16 v[74:75], v25 offset:28544
    s_waitcnt lgkmcnt(6)
    v_mfma_f32_32x32x16_bf16 v[156:171], v[92:95], a[64:67], v[156:171]
    ds_read_b64_tr_b16 v[76:77], v25 offset:30720
    ds_read_b64_tr_b16 v[78:79], v25 offset:31488
    v_mfma_f32_32x32x16_bf16 v[172:187], v[96:99], a[64:67], v[172:187]
    ds_read_b64_tr_b16 v[80:81], v25 offset:30784
    ds_read_b64_tr_b16 v[82:83], v25 offset:31552
    s_waitcnt lgkmcnt(6)
    v_mfma_f32_32x32x16_bf16 v[140:155], v[100:103], a[68:71], v[140:155]
    ds_read_b64_tr_b16 v[84:85], v25 offset:30848
    ds_read_b64_tr_b16 v[86:87], v25 offset:31616
    v_mfma_f32_32x32x16_bf16 v[156:171], v[104:107], a[68:71], v[156:171]
    ds_read_b64_tr_b16 v[88:89], v25 offset:33792
    ds_read_b64_tr_b16 v[90:91], v25 offset:34560
    s_waitcnt lgkmcnt(8)
    v_mfma_f32_32x32x16_bf16 v[172:187], v[72:75], a[68:71], v[172:187]
    ds_read_b64_tr_b16 v[92:93], v25 offset:33856
    ds_read_b64_tr_b16 v[94:95], v25 offset:34624
    s_waitcnt lgkmcnt(8)
    v_mfma_f32_32x32x16_bf16 v[140:155], v[76:79], a[72:75], v[140:155]
    ds_read_b64_tr_b16 v[96:97], v25 offset:33920
    ds_read_b64_tr_b16 v[98:99], v25 offset:34688
Lp_gate1:
    s_waitcnt lgkmcnt(0)
    s_cmp_ge_u32 s32, 64
    s_cbranch_scc0 Lr_gate1
Ld_gate1:
    v_mfma_f32_32x32x16_bf16 v[156:171], v[80:83], a[72:75], v[156:171]
    s_waitcnt vmcnt(9)
    s_atomic_add s91, s[24:25], s82 offset:0
    s_atomic_add s91, s[24:25], s82 offset:2048
    s_atomic_add s91, s[24:25], s82 offset:4096
    s_mul_i32 s72, s93, 196608
    s_add_u32 m0, s67, 0x14000
    s_nop 0
    buffer_load_dwordx4 v12, s[8:11], s72 offen offset:0 lds
    buffer_load_dwordx4 v13, s[8:11], s72 offen offset:1024 lds
    s_xor_b32 s72, s93, 2
    s_mul_i32 s72, s72, 196608
    s_add_u32 m0, s67, 0x16000
    s_nop 0
    buffer_load_dwordx4 v12, s[8:11], s72 offen offset:0 lds
    s_waitcnt vmcnt(9)
    s_barrier
    ds_read_b64_tr_b16 v[100:101], v25 offset:36864
    ds_read_b64_tr_b16 v[102:103], v25 offset:37632
    v_mfma_f32_32x32x16_bf16 v[172:187], v[84:87], a[72:75], v[172:187]
    ds_read_b64_tr_b16 v[104:105], v25 offset:39936
    ds_read_b64_tr_b16 v[106:107], v25 offset:40704
    v_mfma_f32_32x32x16_bf16 v[140:155], v[88:91], a[76:79], v[140:155]
    ds_read_b64_tr_b16 v[72:73], v25 offset:43008
    ds_read_b64_tr_b16 v[74:75], v25 offset:43776
    v_mfma_f32_32x32x16_bf16 v[156:171], v[92:95], a[76:79], v[156:171]
    ds_read_b64_tr_b16 v[76:77], v25 offset:46080
    ds_read_b64_tr_b16 v[78:79], v25 offset:46848
    v_mfma_f32_32x32x16_bf16 v[172:187], v[96:99], a[76:79], v[172:187]
    buffer_load_dwordx4 v13, s[8:11], s72 offen offset:1024 lds
    s_xor_b32 s72, s93, 4
    s_mul_i32 s72, s72, 196608
    s_add_u32 m0, s67, 0x24000
    s_nop 0
    buffer_load_dwordx4 v12, s[8:11], s72 offen offset:0 lds
    s_waitcnt vmcnt(8)
    s_barrier
    ds_read_b64_tr_b16 v[80:81], v26 offset:24576
    ds_read_b64_tr_b16 v[82:83], v26 offset:25344
    s_waitcnt lgkmcnt(8)
    v_mfma_f32_32x32x16_bf16 v[140:155], v[100:103], a[80:83], v[140:155]
    ds_read_b64_tr_b16 v[84:85], v26 offset:27648
    ds_read_b64_tr_b16 v[86:87], v26 offset:28416
    s_waitcnt lgkmcnt(8)
    v_mfma_f32_32x32x16_bf16 v[140:155], v[104:107], a[84:87], v[140:155]
    ds_read_b64_tr_b16 v[88:89], v26 offset:30720
    ds_read_b64_tr_b16 v[90:91], v26 offset:31488
    s_waitcnt lgkmcnt(8)
    v_mfma_f32_32x32x16_bf16 v[140:155], v[72:75], a[88:91], v[140:155]
    ds_read_b64_tr_b16 v[92:93], v26 offset:33792
    ds_read_b64_tr_b16 v[94:95], v26 offset:34560
    s_waitcnt lgkmcnt(8)
    v_mfma_f32_32x32x16_bf16 v[140:155], v[76:79], a[92:95], v[140:155]
    buffer_load_dwordx4 v13, s[8:11], s72 offen offset:1024 lds
    s_xor_b32 s72, s93, 6
    s_mul_i32 s72, s72, 196608
    s_add_u32 m0, s67, 0x26000
    s_nop 0
    buffer_load_dwordx4 v12, s[8:11], s72 offen offset:0 lds
    s_waitcnt vmcnt(7)
    s_barrier
    ds_read_b64_tr_b16 v[96:97], v26 offset:36864
    ds_read_b64_tr_b16 v[98:99], v26 offset:37632
    s_waitcnt lgkmcnt(8)
    v_mfma_f32_32x32x16_bf16 v[140:155], v[80:83], a[96:99], v[140:155]
    ds_read_b64_tr_b16 v[100:101], v26 offset:39936
    ds_read_b64_tr_b16 v[102:103], v26 offset:40704
    s_waitcnt lgkmcnt(8)
    v_mfma_f32_32x32x16_bf16 v[140:155], v[84:87], a[100:103], v[140:155]
    ds_read_b64_tr_b16 v[104:105], v26 offset:43008
    ds_read_b64_tr_b16 v[106:107], v26 offset:43776
    s_waitcnt lgkmcnt(8)
    v_mfma_f32_32x32x16_bf16 v[140:155], v[88:91], a[104:107], v[140:155]
    ds_read_b64_tr_b16 v[72:73], v26 offset:46080
    ds_read_b64_tr_b16 v[74:75], v26 offset:46848
    s_waitcnt lgkmcnt(8)
    v_mfma_f32_32x32x16_bf16 v[140:155], v[92:95], a[108:111], v[140:155]
    ds_read_b64_tr_b16 v[76:77], v25 offset:36928
    ds_read_b64_tr_b16 v[78:79], v25 offset:37696
    s_waitcnt lgkmcnt(8)
    v_mfma_f32_32x32x16_bf16 v[140:155], v[96:99], a[112:115], v[140:155]
    ds_read_b64_tr_b16 v[80:81], v25 offset:40000
    ds_read_b64_tr_b16 v[82:83], v25 offset:40768
    s_waitcnt lgkmcnt(8)
    v_mfma_f32_32x32x16_bf16 v[140:155], v[100:103], a[116:119], v[140:155]
    ds_read_b64_tr_b16 v[84:85], v25 offset:43072
    ds_read_b64_tr_b16 v[86:87], v25 offset:43840
    s_waitcnt lgkmcnt(8)
    v_mfma_f32_32x32x16_bf16 v[140:155], v[104:107], a[120:123], v[140:155]
    ds_read_b64_tr_b16 v[88:89], v25 offset:46144
    ds_read_b64_tr_b16 v[90:91], v25 offset:46912
    s_waitcnt lgkmcnt(8)
    v_mfma_f32_32x32x16_bf16 v[140:155], v[72:75], a[124:127], v[140:155]
    ds_read_b64_tr_b16 v[92:93], v26 offset:24640
    ds_read_b64_tr_b16 v[94:95], v26 offset:25408
    s_waitcnt lgkmcnt(8)
    v_mfma_f32_32x32x16_bf16 v[156:171], v[76:79], a[80:83], v[156:171]
    ds_read_b64_tr_b16 v[96:97], v26 offset:27712
    ds_read_b64_tr_b16 v[98:99], v26 offset:28480
    s_waitcnt lgkmcnt(8)
    v_mfma_f32_32x32x16_bf16 v[156:171], v[80:83], a[84:87], v[156:171]
    ds_read_b64_tr_b16 v[100:101], v26 offset:30784
    ds_read_b64_tr_b16 v[102:103], v26 offset:31552
    s_nop 1
    v_mul_f32 v228, 0xbfb8aa3b, v140
    v_mul_f32 v229, 0xbfb8aa3b, v141
    v_mul_f32 v230, 0xbfb8aa3b, v142
    v_mul_f32 v231, 0xbfb8aa3b, v143
    v_exp_f32 v228, v228
    v_exp_f32 v229, v229
    v_exp_f32 v230, v230
    v_exp_f32 v231, v231
    s_waitcnt lgkmcnt(4)
    v_mfma_f32_32x32x16_bf16 v[156:171], v[84:87], a[88:91], v[156:171]
    s_load_dword s92, s[24:25], s82 glc
    ds_read_b64_tr_b16 v[104:105], v26 offset:33856
    ds_read_b64_tr_b16 v[106:107], v26 offset:34624
    v_add_f32 v228, 1.0, v228
    v_add_f32 v229, 1.0, v229
    v_add_f32 v230, 1.0, v230
    v_add_f32 v231, 1.0, v231
    v_rcp_f32 v228, v228
    v_rcp_f32 v229, v229
    v_rcp_f32 v230, v230
    v_rcp_f32 v231, v231
    v_mfma_f32_32x32x16_bf16 v[156:171], v[88:91], a[92:95], v[156:171]
    ds_read_b64_tr_b16 v[72:73], v26 offset:36928
    ds_read_b64_tr_b16 v[74:75], v26 offset:37696
    v_mul_f32 v140, v140, v228
    v_mul_f32 v141, v141, v229
    v_mul_f32 v142, v142, v230
    v_mul_f32 v143, v143, v231
    v_cvt_pk_bf16_f32 v232, v140, v141
    v_cvt_pk_bf16_f32 v233, v142, v143
    v_mul_f32 v228, 0xbfb8aa3b, v144
    v_mul_f32 v229, 0xbfb8aa3b, v145
    v_mfma_f32_32x32x16_bf16 v[156:171], v[92:95], a[96:99], v[156:171]
    ds_read_b64_tr_b16 v[76:77], v26 offset:40000
    ds_read_b64_tr_b16 v[78:79], v26 offset:40768
    v_mul_f32 v230, 0xbfb8aa3b, v146
    v_mul_f32 v231, 0xbfb8aa3b, v147
    v_exp_f32 v228, v228
    v_exp_f32 v229, v229
    v_exp_f32 v230, v230
    v_exp_f32 v231, v231
    v_add_f32 v228, 1.0, v228
    v_add_f32 v229, 1.0, v229
    s_waitcnt lgkmcnt(8)
    v_mfma_f32_32x32x16_bf16 v[156:171], v[96:99], a[100:103], v[156:171]
    ds_read_b64_tr_b16 v[80:81], v26 offset:43072
    ds_read_b64_tr_b16 v[82:83], v26 offset:43840
    v_add_f32 v230, 1.0, v230
    v_add_f32 v231, 1.0, v231
    v_rcp_f32 v228, v228
    v_rcp_f32 v229, v229
    v_rcp_f32 v230, v230
    v_rcp_f32 v231, v231
    v_mul_f32 v144, v144, v228
    v_mul_f32 v145, v145, v229
    s_waitcnt lgkmcnt(8)
    v_mfma_f32_32x32x16_bf16 v[156:171], v[100:103], a[104:107], v[156:171]
    ds_read_b64_tr_b16 v[84:85], v26 offset:46144
    ds_read_b64_tr_b16 v[86:87], v26 offset:46912
    v_mul_f32 v146, v146, v230
    v_mul_f32 v147, v147, v231
    v_cvt_pk_bf16_f32 v234, v144, v145
    v_cvt_pk_bf16_f32 v235, v146, v147
    v_mul_f32 v228, 0xbfb8aa3b, v148
    v_mul_f32 v229, 0xbfb8aa3b, v149
    v_mul_f32 v230, 0xbfb8aa3b, v150
    s_add_u32 s73, s78, 0x0
    s_waitcnt lgkmcnt(8)
    v_mfma_f32_32x32x16_bf16 v[156:171], v[104:107], a[108:111], v[156:171]
    buffer_store_dwordx4 v[232:235], v8, s[24:27], s73 offen offset:0 sc1
    ds_read_b64_tr_b16 v[88:89], v25 offset:36992
    ds_read_b64_tr_b16 v[90:91], v25 offset:37760
    v_mul_f32 v231, 0xbfb8aa3b, v151
    v_exp_f32 v228, v228
    v_exp_f32 v229, v229
    v_exp_f32 v230, v230
    v_exp_f32 v231, v231
    v_add_f32 v228, 1.0, v228
    v_add_f32 v229, 1.0, v229
    s_waitcnt lgkmcnt(8)
    v_mfma_f32_32x32x16_bf16 v[156:171], v[72:75], a[112:115], v[156:171]
    ds_read_b64_tr_b16 v[92:93], v25 offset:40064
    ds_read_b64_tr_b16 v[94:95], v25 offset:40832
    v_add_f32 v230, 1.0, v230
    v_add_f32 v231, 1.0, v231
    v_rcp_f32 v228, v228
    v_rcp_f32 v229, v229
    v_rcp_f32 v230, v230
    v_rcp_f32 v231, v231
    v_mul_f32 v148, v148, v228
    s_waitcnt lgkmcnt(8)
    v_mfma_f32_32x32x16_bf16 v[156:171], v[76:79], a[116:119], v[156:171]
    ds_read_b64_tr_b16 v[96:97], v25 offset:43136
    ds_read_b64_tr_b16 v[98:99], v25 offset:43904
    v_mul_f32 v149, v149, v229
    v_mul_f32 v150, v150, v230
    v_mul_f32 v151, v151, v231
    v_cvt_pk_bf16_f32 v236, v148, v149
    v_cvt_pk_bf16_f32 v237, v150, v151
    v_mul_f32 v228, 0xbfb8aa3b, v152
    v_mul_f32 v229, 0xbfb8aa3b, v153
    s_waitcnt lgkmcnt(8)
    v_mfma_f32_32x32x16_bf16 v[156:171], v[80:83], a[120:123], v[156:171]
    ds_read_b64_tr_b16 v[100:101], v25 offset:46208
    ds_read_b64_tr_b16 v[102:103], v25 offset:46976
    v_mul_f32 v230, 0xbfb8aa3b, v154
    v_mul_f32 v231, 0xbfb8aa3b, v155
    v_exp_f32 v228, v228
    v_exp_f32 v229, v229
    v_exp_f32 v230, v230
    v_exp_f32 v231, v231
    v_add_f32 v228, 1.0, v228
    s_waitcnt lgkmcnt(8)
    v_mfma_f32_32x32x16_bf16 v[156:171], v[84:87], a[124:127], v[156:171]
    buffer_load_dwordx4 v13, s[8:11], s72 offen offset:1024 lds
    ds_read_b64_tr_b16 v[104:105], v26 offset:24704
    ds_read_b64_tr_b16 v[106:107], v26 offset:25472
    v_add_f32 v229, 1.0, v229
    v_add_f32 v230, 1.0, v230
    v_add_f32 v231, 1.0, v231
    v_rcp_f32 v228, v228
    v_rcp_f32 v229, v229
    v_rcp_f32 v230, v230
    v_rcp_f32 v231, v231
    s_waitcnt lgkmcnt(8)
    v_mfma_f32_32x32x16_bf16 v[172:187], v[88:91], a[80:83], v[172:187]
Lp_kv2:
    s_waitcnt lgkmcnt(0)
    s_and_b32 s40, s92, 0xff
    s_cmp_eq_u32 s40, s83
    s_cbranch_scc0 Lr_kv2
Ld_kv2:
    ds_read_b64_tr_b16 v[72:73], v26 offset:27776
    ds_read_b64_tr_b16 v[74:75], v26 offset:28544
    v_mul_f32 v152, v152, v228
    v_mul_f32 v153, v153, v229
    v_mul_f32 v154, v154, v230
    v_mul_f32 v155, v155, v231
    v_cvt_pk_bf16_f32 v238, v152, v153
    v_cvt_pk_bf16_f32 v239, v154, v155
    s_add_u32 m0, s69, 0x18000
    v_mfma_f32_32x32x16_bf16 v[172:187], v[92:95], a[84:87], v[172:187]
    buffer_load_dwordx4 v1, s[24:27], s74 offen offset:0 sc1 lds
    ds_read_b64_tr_b16 v[76:77], v26 offset:30848
    ds_read_b64_tr_b16 v[78:79], v26 offset:31616
    v_mul_f32 v228, 0xbfb8aa3b, v156
    v_mul_f32 v229, 0xbfb8aa3b, v157
    v_mul_f32 v230, 0xbfb8aa3b, v158
    v_mul_f32 v231, 0xbfb8aa3b, v159
    v_exp_f32 v228, v228
    v_exp_f32 v229, v229
    v_exp_f32 v230, v230
    v_exp_f32 v231, v231
    v_mfma_f32_32x32x16_bf16 v[172:187], v[96:99], a[88:91], v[172:187]
    buffer_load_dwordx4 v1, s[24:27], s74 offen offset:1024 sc1 lds
    ds_read_b64_tr_b16 v[80:81], v26 offset:33920
    ds_read_b64_tr_b16 v[82:83], v26 offset:34688
    v_add_f32 v228, 1.0, v228
    v_add_f32 v229, 1.0, v229
    v_add_f32 v230, 1.0, v230
    v_add_f32 v231, 1.0, v231
    v_rcp_f32 v228, v228
    v_rcp_f32 v229, v229
    v_rcp_f32 v230, v230
    v_rcp_f32 v231, v231
    s_xor_b32 s72, s74, 0x8800
    s_add_u32 m0, s71, 0x0
    v_mfma_f32_32x32x16_bf16 v[172:187], v[100:103], a[92:95], v[172:187]
    buffer_load_dwordx4 v1, s[24:27], s72 offen offset:0 sc1 lds
    ds_read_b64_tr_b16 v[84:85], v26 offset:36992
    ds_read_b64_tr_b16 v[86:87], v26 offset:37760
    v_mul_f32 v156, v156, v228
    v_mul_f32 v157, v157, v229
    v_mul_f32 v158, v158, v230
    v_mul_f32 v159, v159, v231
    v_cvt_pk_bf16_f32 v240, v156, v157
    v_cvt_pk_bf16_f32 v241, v158, v159
    v_mul_f32 v228, 0xbfb8aa3b, v160
    v_mul_f32 v229, 0xbfb8aa3b, v161
    s_add_u32 m0, s71, 0x100
    v_mfma_f32_32x32x16_bf16 v[172:187], v[104:107], a[96:99], v[172:187]
    buffer_load_dwordx4 v1, s[24:27], s72 offen offset:1024 sc1 lds
    ds_read_b64_tr_b16 v[88:89], v26 offset:40064
    ds_read_b64_tr_b16 v[90:91], v26 offset:40832
    v_mul_f32 v230, 0xbfb8aa3b, v162
    v_mul_f32 v231, 0xbfb8aa3b, v163
    v_exp_f32 v228, v228
    v_exp_f32 v229, v229
    v_exp_f32 v230, v230
    v_exp_f32 v231, v231
    v_add_f32 v228, 1.0, v228
    v_add_f32 v229, 1.0, v229
    s_add_u32 m0, s69, 0x18800
    s_waitcnt lgkmcnt(2)
    v_mfma_f32_32x32x16_bf16 v[172:187], v[72:75], a[100:103], v[172:187]
    buffer_load_dwordx4 v1, s[24:27], s75 offen offset:0 sc1 lds
    ds_read_b64_tr_b16 v[92:93], v26 offset:43136
    ds_read_b64_tr_b16 v[94:95], v26 offset:43904
    v_add_f32 v230, 1.0, v230
Lt_1:
    s_cbranch_execz Lt_back
    v_add_f32 v231, 1.0, v231
    v_rcp_f32 v228, v228
    v_rcp_f32 v229, v229
    v_rcp_f32 v230, v230
    v_rcp_f32 v231, v231
    v_mul_f32 v160, v160, v228
    v_mul_f32 v161, v161, v229
    v_mfma_f32_32x32x16_bf16 v[172:187], v[76:79], a[104:107], v[172:187]
    buffer_load_dwordx4 v1, s[24:27], s75 offen offset:1024 sc1 lds
    ds_read_b64_tr_b16 v[96:97], v26 offset:46208
    ds_read_b64_tr_b16 v[98:99], v26 offset:46976
    v_mul_f32 v162, v162, v230
    v_mul_f32 v163, v163, v231
    v_cvt_pk_bf16_f32 v242, v160, v161
    v_cvt_pk_bf16_f32 v243, v162, v163
    v_mul_f32 v228, 0xbfb8aa3b, v164
    v_mul_f32 v229, 0xbfb8aa3b, v165
    s_xor_b32 s72, s75, 0x8800
    s_add_u32 m0, s71, 0xa00
    v_mfma_f32_32x32x16_bf16 v[172:187], v[80:83], a[108:111], v[172:187]
    buffer_load_dwordx4 v1, s[24:27], s72 offen offset:0 sc1 lds
    s_waitcnt vmcnt(14)
    s_barrier
    ds_read_b64_tr_b16 v[100:101], v27 offset:0
    ds_read_b64_tr_b16 v[102:103], v27 offset:256
    v_mul_f32 v230, 0xbfb8aa3b, v166
    v_mul_f32 v231, 0xbfb8aa3b, v167
    v_exp_f32 v228, v228
    v_exp_f32 v229, v229
    v_exp_f32 v230, v230
    v_exp_f32 v231, v231
    v_add_f32 v228, 1.0, v228
    v_add_f32 v229, 1.0, v229
    s_add_u32 m0, s71, 0xb00
    v_mfma_f32_32x32x16_bf16 v[172:187], v[84:87], a[112:115], v[172:187]
    buffer_load_dwordx4 v1, s[24:27], s72 offen offset:1024 sc1 lds
    ds_read_b64_tr_b16 v[104:105], v27 offset:1024
    ds_read_b64_tr_b16 v[106:107], v27 offset:1280
    v_add_f32 v230, 1.0, v230
    v_add_f32 v231, 1.0, v231
    v_rcp_f32 v228, v228
    v_rcp_f32 v229, v229
    v_rcp_f32 v230, v230
    v_rcp_f32 v231, v231
    v_mul_f32 v164, v164, v228
    v_mul_f32 v165, v165, v229
    s_mov_b32 m0, s70
    s_waitcnt lgkmcnt(2)
    v_mfma_f32_32x32x16_bf16 v[172:187], v[88:91], a[116:119], v[172:187]
    buffer_load_dwordx4 v1, s[24:27], s76 offen offset:0 sc1 lds
    ds_read_b64_tr_b16 v[72:73], v27 offset:2048
    ds_read_b64_tr_b16 v[74:75], v27 offset:2304
    v_mul_f32 v166, v166, v230
    v_mul_f32 v167, v167, v231
    v_cvt_pk_bf16_f32 v232, v164, v165
    v_cvt_pk_bf16_f32 v233, v166, v167
    v_mul_f32 v228, 0xbfb8aa3b, v168
    v_mul_f32 v229, 0xbfb8aa3b, v169
    v_mul_f32 v230, 0xbfb8aa3b, v170
    s_bitcmp0_b32 s66, 0
    s_cselect_b32 s97, 0x100, 0
    s_add_u32 m0, s70, s97
    v_mfma_f32_32x32x16_bf16 v[172:187], v[92:95], a[120:123], v[172:187]
    buffer_load_dwordx4 v1, s[24:27], s76 offen offset:1024 sc1 lds
    ds_read_b64_tr_b16 v[76:77], v27 offset:3072
    ds_read_b64_tr_b16 v[78:79], v27 offset:3328
    v_mul_f32 v231, 0xbfb8aa3b, v171
    v_exp_f32 v228, v228
    v_exp_f32 v229, v229
    v_exp_f32 v230, v230
    v_exp_f32 v231, v231
    v_add_f32 v228, 1.0, v228
    v_add_f32 v229, 1.0, v229
    v_mfma_f32_32x32x16_bf16 v[172:187], v[96:99], a[124:127], v[172:187]
    buffer_store_dwordx4 v[236:239], v8, s[24:27], s73 offen offset:512 sc1
    ds_read_b64_tr_b16 v[80:81], v27 offset:4096
    ds_read_b64_tr_b16 v[82:83], v27 offset:4352
    v_add_f32 v230, 1.0, v230
    v_add_f32 v231, 1.0, v231
    v_rcp_f32 v228, v228
    v_rcp_f32 v229, v229
    v_rcp_f32 v230, v230
    v_rcp_f32 v231, v231
    v_mul_f32 v168, v168, v228
    v_mfma_f32_32x32x16_bf16 v[188:203], v[100:103], a[0:3], 0
    ds_read_b64_tr_b16 v[84:85], v27 offset:5120
    ds_read_b64_tr_b16 v[86:87], v27 offset:5376
    v_mul_f32 v169, v169, v229
    v_mul_f32 v170, v170, v230
    v_mul_f32 v171, v171, v231
    v_cvt_pk_bf16_f32 v234, v168, v169
    v_cvt_pk_bf16_f32 v235, v170, v171
    s_waitcnt lgkmcnt(4)
    v_mfma_f32_32x32x16_bf16 v[188:203], v[104:107], a[4:7], v[188:203]
    ds_read_b64_tr_b16 v[88:89], v27 offset:6144
    ds_read_b64_tr_b16 v[90:91], v27 offset:6400
    v_mul_f32 v228, 0xbfb8aa3b, v172
    v_mul_f32 v229, 0xbfb8aa3b, v173
    v_mul_f32 v230, 0xbfb8aa3b, v174
    v_mul_f32 v231, 0xbfb8aa3b, v175
    v_exp_f32 v228, v228
    v_exp_f32 v229, v229
    v_exp_f32 v230, v230
    v_exp_f32 v231, v231
    v_mfma_f32_32x32x16_bf16 v[188:203], v[72:75], a[8:11], v[188:203]
    ds_read_b64_tr_b16 v[92:93], v27 offset:7168
    ds_read_b64_tr_b16 v[94:95], v27 offset:7424
    v_add_f32 v228, 1.0, v228
    v_add_f32 v229, 1.0, v229
    v_add_f32 v230, 1.0, v230
    v_add_f32 v231, 1.0, v231
    v_rcp_f32 v228, v228
    v_rcp_f32 v229, v229
    v_rcp_f32 v230, v230
    v_rcp_f32 v231, v231
    v_mfma_f32_32x32x16_bf16 v[188:203], v[76:79], a[12:15], v[188:203]
    s_waitcnt vmcnt(16)
    s_barrier
    ds_read_b64_tr_b16 v[96:97], v27 offset:8192
    ds_read_b64_tr_b16 v[98:99], v27 offset:8448
    v_mul_f32 v172, v172, v228
    v_mul_f32 v173, v173, v229
    v_mul_f32 v174, v174, v230
    v_mul_f32 v175, v175, v231
    v_cvt_pk_bf16_f32 v236, v172, v173
    v_cvt_pk_bf16_f32 v237, v174, v175
    v_mul_f32 v228, 0xbfb8aa3b, v176
    v_mul_f32 v229, 0xbfb8aa3b, v177
    s_add_u32 s73, s38, 0x0
    s_waitcnt lgkmcnt(2)
    v_mfma_f32_32x32x16_bf16 v[188:203], v[80:83], a[16:19], v[188:203]
    buffer_store_dwordx4 v[240:243], v8, s[24:27], s73 offen offset:2048 sc1
    ds_read_b64_tr_b16 v[100:101], v27 offset:9216
    ds_read_b64_tr_b16 v[102:103], v27 offset:9472
    v_mul_f32 v230, 0xbfb8aa3b, v178
    v_mul_f32 v231, 0xbfb8aa3b, v179
    v_exp_f32 v228, v228
    v_exp_f32 v229, v229
    v_exp_f32 v230, v230
    v_exp_f32 v231, v231
    v_add_f32 v228, 1.0, v228
    v_add_f32 v229, 1.0, v229
    v_mfma_f32_32x32x16_bf16 v[188:203], v[84:87], a[20:23], v[188:203]
    ds_read_b64_tr_b16 v[104:105], v27 offset:10240
    ds_read_b64_tr_b16 v[106:107], v27 offset:10496
    v_add_f32 v230, 1.0, v230
    v_add_f32 v231, 1.0, v231
    v_rcp_f32 v228, v228
    v_rcp_f32 v229, v229
    v_rcp_f32 v230, v230
    v_rcp_f32 v231, v231
    v_mul_f32 v176, v176, v228
    v_mul_f32 v177, v177, v229
    v_mfma_f32_32x32x16_bf16 v[188:203], v[88:91], a[24:27], v[188:203]
    buffer_store_dwordx4 v[232:235], v8, s[24:27], s73 offen offset:2560 sc1
    ds_read_b64_tr_b16 v[72:73], v27 offset:11264
    ds_read_b64_tr_b16 v[74:75], v27 offset:11520
    v_mul_f32 v178, v178, v230
    v_mul_f32 v179, v179, v231
    v_cvt_pk_bf16_f32 v238, v176, v177
    v_cvt_pk_bf16_f32 v239, v178, v179
    v_mul_f32 v228, 0xbfb8aa3b, v180
    v_mul_f32 v229, 0xbfb8aa3b, v181
    s_add_u32 s73, s38, 0x1000
    v_mfma_f32_32x32x16_bf16 v[188:203], v[92:95], a[28:31], v[188:203]
    buffer_store_dwordx4 v[236:239], v8, s[24:27], s73 offen offset:0 sc1
    ds_read_b64_tr_b16 v[76:77], v27 offset:12288
    ds_read_b64_tr_b16 v[78:79], v27 offset:12544
    v_mul_f32 v230, 0xbfb8aa3b, v182
    v_mul_f32 v231, 0xbfb8aa3b, v183
    v_exp_f32 v228, v228
    v_exp_f32 v229, v229
    v_exp_f32 v230, v230
    v_exp_f32 v231, v231
    v_add_f32 v228, 1.0, v228
    v_add_f32 v229, 1.0, v229
    s_waitcnt lgkmcnt(4)
    v_mfma_f32_32x32x16_bf16 v[188:203], v[96:99], a[32:35], v[188:203]
    ds_read_b64_tr_b16 v[80:81], v27 offset:13312
    ds_read_b64_tr_b16 v[82:83], v27 offset:13568
    v_add_f32 v230, 1.0, v230
    v_add_f32 v231, 1.0, v231
    v_rcp_f32 v228, v228
    v_rcp_f32 v229, v229
    v_rcp_f32 v230, v230
    v_rcp_f32 v231, v231
    v_mul_f32 v180, v180, v228
    v_mul_f32 v181, v181, v229
    v_mfma_f32_32x32x16_bf16 v[188:203], v[100:103], a[36:39], v[188:203]
    ds_read_b64_tr_b16 v[84:85], v27 offset:14336
    ds_read_b64_tr_b16 v[86:87], v27 offset:14592
    v_mul_f32 v182, v182, v230
    v_mul_f32 v183, v183, v231
    v_cvt_pk_bf16_f32 v240, v180, v181
    v_cvt_pk_bf16_f32 v241, v182, v183
    v_mul_f32 v228, 0xbfb8aa3b, v184
    v_mul_f32 v229, 0xbfb8aa3b, v185
    v_mul_f32 v230, 0xbfb8aa3b, v186
    v_mfma_f32_32x32x16_bf16 v[188:203], v[104:107], a[40:43], v[188:203]
    ds_read_b64_tr_b16 v[88:89], v27 offset:15360
    ds_read_b64_tr_b16 v[90:91], v27 offset:15616
    v_mul_f32 v231, 0xbfb8aa3b, v187
    v_exp_f32 v228, v228
    v_exp_f32 v229, v229
    v_exp_f32 v230, v230
    v_exp_f32 v231, v231
    v_add_f32 v228, 1.0, v228
    v_add_f32 v229, 1.0, v229
    s_waitcnt lgkmcnt(4)
    v_mfma_f32_32x32x16_bf16 v[188:203], v[72:75], a[44:47], v[188:203]
    s_waitcnt vmcnt(17)
    s_barrier
    ds_read_b64_tr_b16 v[92:93], v28 offset:0
    ds_read_b64_tr_b16 v[94:95], v28 offset:256
    v_add_f32 v230, 1.0, v230
    v_add_f32 v231, 1.0, v231
    v_rcp_f32 v228, v228
    v_rcp_f32 v229, v229
    v_rcp_f32 v230, v230
    v_rcp_f32 v231, v231
    v_mul_f32 v184, v184, v228
    v_mfma_f32_32x32x16_bf16 v[188:203], v[76:79], a[48:51], v[188:203]
    ds_read_b64_tr_b16 v[96:97], v28 offset:1024
    ds_read_b64_tr_b16 v[98:99], v28 offset:1280
    v_mul_f32 v185, v185, v229
    v_mul_f32 v186, v186, v230
    v_mul_f32 v187, v187, v231
    v_cvt_pk_bf16_f32 v242, v184, v185
    v_cvt_pk_bf16_f32 v243, v186, v187
    v_mfma_f32_32x32x16_bf16 v[188:203], v[80:83], a[52:55], v[188:203]
    buffer_store_dwordx4 v[240:243], v8, s[24:27], s73 offen offset:512 sc1
    ds_read_b64_tr_b16 v[100:101], v28 offset:2048
    ds_read_b64_tr_b16 v[102:103], v28 offset:2304
    s_lshr_b32 s97, s2, 3
    s_lshl2_add_u32 s97, s97, s64
    s_cmp_lt_u32 s97, 86
    s_cselect_b32 s73, 0, 86
    s_cselect_b64 s[60:61], s[16:17], s[20:21]
    s_cselect_b32 s62, s18, s22
    s_mov_b32 s63, s7
    s_sub_u32 s73, s97, s73
    s_lshl_b32 s73, s73, 14
    v_lshrrev_b32 v3, 6, v1
    v_lshlrev_b32 v3, 10, v3
    s_waitcnt lgkmcnt(4)
    v_mfma_f32_32x32x16_bf16 v[188:203], v[84:87], a[56:59], v[188:203]
    buffer_load_dword v2, v3, s[60:63], s73 offen offset:384
    ds_read_b64_tr_b16 v[104:105], v28 offset:3072
    ds_read_b64_tr_b16 v[106:107], v28 offset:3328
    s_add_u32 s72, s3, s95
    s_add_u32 m0, s69, 0x8000
    v_mfma_f32_32x32x16_bf16 v[188:203], v[88:91], a[60:63], v[188:203]
    buffer_load_dwordx4 v14, s[16:19], s72 offen offset:0 lds
    ds_read_b64_tr_b16 v[72:73], v28 offset:4096
    ds_read_b64_tr_b16 v[74:75], v28 offset:4352
    v_mfma_f32_32x32x16_bf16 v[188:203], v[92:95], a[64:67], v[188:203]
    buffer_load_dwordx4 v15, s[16:19], s72 offen offset:1024 lds
    ds_read_b64_tr_b16 v[76:77], v28 offset:5120
    ds_read_b64_tr_b16 v[78:79], v28 offset:5376
    s_waitcnt lgkmcnt(6)
    v_mfma_f32_32x32x16_bf16 v[188:203], v[96:99], a[68:71], v[188:203]
    buffer_load_dwordx4 v16, s[16:19], s72 offen offset:2048 lds
    ds_read_b64_tr_b16 v[80:81], v28 offset:6144
    ds_read_b64_tr_b16 v[82:83], v28 offset:6400
    v_mfma_f32_32x32x16_bf16 v[188:203], v[100:103], a[72:75], v[188:203]
    ds_read_b64_tr_b16 v[84:85], v28 offset:7168
    ds_read_b64_tr_b16 v[86:87], v28 offset:7424
    s_waitcnt lgkmcnt(8)
    v_mfma_f32_32x32x16_bf16 v[188:203], v[104:107], a[76:79], v[188:203]
    s_waitcnt vmcnt(19)
    s_barrier
    ds_read_b64_tr_b16 v[88:89], v28 offset:8192
    ds_read_b64_tr_b16 v[90:91], v28 offset:8448
    s_waitcnt lgkmcnt(6)
    v_mfma_f32_32x32x16_bf16 v[188:203], v[72:75], a[80:83], v[188:203]
    ds_read_b64_tr_b16 v[92:93], v28 offset:9216
    ds_read_b64_tr_b16 v[94:95], v28 offset:9472
    v_mfma_f32_32x32x16_bf16 v[188:203], v[76:79], a[84:87], v[188:203]
    ds_read_b64_tr_b16 v[96:97], v28 offset:10240
    ds_read_b64_tr_b16 v[98:99], v28 offset:10496
    s_waitcnt lgkmcnt(6)
    v_mfma_f32_32x32x16_bf16 v[188:203], v[80:83], a[88:91], v[188:203]
    ds_read_b64_tr_b16 v[100:101], v28 offset:11264
    ds_read_b64_tr_b16 v[102:103], v28 offset:11520
    v_mfma_f32_32x32x16_bf16 v[188:203], v[84:87], a[92:95], v[188:203]
    ds_read_b64_tr_b16 v[104:105], v28 offset:12288
    ds_read_b64_tr_b16 v[106:107], v28 offset:12544
    s_waitcnt lgkmcnt(8)
    v_mfma_f32_32x32x16_bf16 v[188:203], v[88:91], a[96:99], v[188:203]
    ds_read_b64_tr_b16 v[72:73], v28 offset:13312
    ds_read_b64_tr_b16 v[74:75], v28 offset:13568
    s_waitcnt lgkmcnt(8)
    v_mfma_f32_32x32x16_bf16 v[188:203], v[92:95], a[100:103], v[188:203]
    ds_read_b64_tr_b16 v[76:77], v28 offset:14336
    ds_read_b64_tr_b16 v[78:79], v28 offset:14592
    s_waitcnt lgkmcnt(8)
    v_mfma_f32_32x32x16_bf16 v[188:203], v[96:99], a[104:107], v[188:203]
    ds_read_b64_tr_b16 v[80:81], v28 offset:15360
    ds_read_b64_tr_b16 v[82:83], v28 offset:15616
    s_waitcnt lgkmcnt(8)
    v_mfma_f32_32x32x16_bf16 v[188:203], v[100:103], a[108:111], v[188:203]
    buffer_load_dwordx4 v17, s[16:19], s72 offen offset:3072 lds
    s_waitcnt lgkmcnt(6)
    v_mfma_f32_32x32x16_bf16 v[188:203], v[104:107], a[112:115], v[188:203]
    s_waitcnt lgkmcnt(4)
    v_mfma_f32_32x32x16_bf16 v[188:203], v[72:75], a[116:119], v[188:203]
    s_waitcnt lgkmcnt(2)
    v_mfma_f32_32x32x16_bf16 v[188:203], v[76:79], a[120:123], v[188:203]
    s_waitcnt lgkmcnt(0)
    v_mfma_f32_32x32x16_bf16 v[188:203], v[80:83], a[124:127], v[188:203]
    s_lshr_b32 s68, s66, 3
    s_lshl_b32 s68, s68, 7
    s_add_u32 s68, s68, s84
    s_mov_b32 s97, 0x41666666
    v_and_b32 v39, 0xf0, v39
    s_lshr_b32 s40, s96, 8
    v_add_u32 v11, s40, v1
    v_xor_b32 v10, 0x400, v11
    s_xor_b32 s72, s3, 0x10000
    s_add_u32 s72, s72, s95
    s_add_u32 m0, s69, 0xc000
    s_nop 0
    buffer_load_dwordx4 v14, s[16:19], s72 offen offset:0 lds
    v_mul_f32 v188, 0x3eb8aa3b, v188
    v_mul_f32 v189, 0x3eb8aa3b, v189
    v_mul_f32 v190, 0x3eb8aa3b, v190
    v_mul_f32 v191, 0x3eb8aa3b, v191
    v_mul_f32 v192, 0x3eb8aa3b, v192
    v_mul_f32 v193, 0x3eb8aa3b, v193
    v_mul_f32 v194, 0x3eb8aa3b, v194
    v_mul_f32 v195, 0x3eb8aa3b, v195
    v_mul_f32 v196, 0x3eb8aa3b, v196
    v_mul_f32 v197, 0x3eb8aa3b, v197
    v_mul_f32 v198, 0x3eb8aa3b, v198
    v_mul_f32 v199, 0x3eb8aa3b, v199
    v_mul_f32 v200, 0x3eb8aa3b, v200
    v_mul_f32 v201, 0x3eb8aa3b, v201
    v_mul_f32 v202, 0x3eb8aa3b, v202
    v_mul_f32 v203, 0x3eb8aa3b, v203
    v_cvt_pk_bf16_f32 v204, v188, v189
    v_cvt_pk_bf16_f32 v205, v190, v191
    v_cvt_pk_bf16_f32 v206, v192, v193
    v_cvt_pk_bf16_f32 v207, v194, v195
    v_cvt_pk_bf16_f32 v208, v196, v197
    v_cvt_pk_bf16_f32 v209, v198, v199
    v_cvt_pk_bf16_f32 v210, v200, v201
    v_cvt_pk_bf16_f32 v211, v202, v203
    v_dot2_f32_bf16 v228, v204, v204, 0
    v_dot2_f32_bf16 v229, v208, v208, 0
    v_dot2_f32_bf16 v228, v205, v205, v228
    v_dot2_f32_bf16 v229, v209, v209, v229
    v_dot2_f32_bf16 v228, v206, v206, v228
    v_dot2_f32_bf16 v229, v210, v210, v229
    v_dot2_f32_bf16 v228, v207, v207, v228
    v_dot2_f32_bf16 v229, v211, v211, v229
    s_nop 1
    v_cmp_nle_f32 s[40:41], v228, s97
    v_cmp_nle_f32 s[42:43], v229, s97
    s_lshr_b32 s92, s92, 8
    s_or_b64 s[40:41], s[40:41], s[42:43]
    s_cselect_b32 s92, 1, s92
    s_waitcnt vmcnt(11)
    s_barrier
    ds_read_b128 v[72:75], v29 offset:0
    ds_read_b128 v[76:79], v29 offset:2048
    s_cmp_eq_u32 s92, 0
    s_waitcnt lgkmcnt(1)
    v_mfma_f32_32x32x16_bf16 v[108:123], v[72:75], v[204:207], v[56:71]
    s_cbranch_scc0 L_slow
    s_waitcnt lgkmcnt(0)
    v_mfma_f32_32x32x16_bf16 v[124:139], v[76:79], v[204:207], 0
    ds_read_b128 v[72:75], v29 offset:4096
    s_waitcnt vmcnt(6)
    s_atomic_add s86, s[24:25], s84 offset:0
    s_atomic_add s86, s[24:25], s84 offset:128
    s_nop 4
    v_exp_f32 v188, v108
    v_exp_f32 v189, v109
    v_exp_f32 v190, v110
    v_exp_f32 v191, v111
    v_exp_f32 v192, v112
    v_exp_f32 v193, v113
    v_cvt_pk_bf16_f32 v212, v188, v189
    v_cvt_pk_bf16_f32 v213, v190, v191
    ds_read_b128 v[80:83], v30 offset:0
    buffer_load_dwordx4 v15, s[16:19], s72 offen offset:1024 lds
    v_exp_f32 v194, v114
    v_exp_f32 v195, v115
    v_exp_f32 v196, v116
    v_exp_f32 v197, v117
    v_exp_f32 v198, v118
    v_cvt_pk_bf16_f32 v214, v192, v193
    v_cvt_pk_bf16_f32 v215, v194, v195
    v_cvt_pk_bf16_f32 v216, v196, v197
    ds_read_b128 v[84:87], v30 offset:1280
    buffer_load_dwordx4 v16, s[16:19], s72 offen offset:2048 lds
    v_exp_f32 v199, v119
    v_exp_f32 v200, v120
    v_exp_f32 v201, v121
    v_exp_f32 v202, v122
    v_exp_f32 v203, v123
    v_cvt_pk_bf16_f32 v217, v198, v199
    v_cvt_pk_bf16_f32 v218, v200, v201
    v_cvt_pk_bf16_f32 v219, v202, v203
    s_waitcnt lgkmcnt(2)
    v_mfma_f32_32x32x16_bf16 v[108:123], v[72:75], v[204:207], 0
    ds_read_b128 v[76:79], v29 offset:6144
    buffer_load_dwordx4 v17, s[16:19], s72 offen offset:3072 lds
    v_exp_f32 v188, v124
    v_exp_f32 v189, v125
    v_exp_f32 v190, v126
    v_exp_f32 v191, v127
    v_exp_f32 v192, v128
    v_exp_f32 v193, v129
    v_cvt_pk_bf16_f32 v220, v188, v189
    v_cvt_pk_bf16_f32 v221, v190, v191
    s_xor_b32 s72, s3, 0x20000
    s_add_u32 s72, s72, s95
    s_add_u32 m0, s69, 0x10000
    s_waitcnt lgkmcnt(2)
    v_mfma_f32_32x32x16_bf16 v[140:155], v[80:83], v[212:215], 0
    ds_read_b128 v[88:91], v30 offset:2560
    buffer_load_dwordx4 v14, s[16:19], s72 offen offset:0 lds
    v_exp_f32 v194, v130
    v_exp_f32 v195, v131
    v_exp_f32 v196, v132
    v_exp_f32 v197, v133
    v_exp_f32 v198, v134
    v_cvt_pk_bf16_f32 v222, v192, v193
    v_cvt_pk_bf16_f32 v223, v194, v195
    v_cvt_pk_bf16_f32 v224, v196, v197
    s_waitcnt lgkmcnt(2)
    v_mfma_f32_32x32x16_bf16 v[140:155], v[84:87], v[216:219], v[140:155]
    ds_read_b128 v[92:95], v30 offset:3840
    buffer_load_dwordx4 v15, s[16:19], s72 offen offset:1024 lds
    v_exp_f32 v199, v135
    v_exp_f32 v200, v136
    v_exp_f32 v201, v137
    v_exp_f32 v202, v138
    v_exp_f32 v203, v139
    v_cvt_pk_bf16_f32 v225, v198, v199
    v_cvt_pk_bf16_f32 v226, v200, v201
    v_cvt_pk_bf16_f32 v227, v202, v203
    s_waitcnt lgkmcnt(2)
    v_mfma_f32_32x32x16_bf16 v[124:139], v[76:79], v[204:207], 0
    ds_read_b128 v[72:75], v29 offset:8192
    buffer_load_dwordx4 v16, s[16:19], s72 offen offset:2048 lds
    v_exp_f32 v188, v108
    v_exp_f32 v189, v109
    v_exp_f32 v190, v110
    v_exp_f32 v191, v111
    v_exp_f32 v192, v112
    v_exp_f32 v193, v113
    v_cvt_pk_bf16_f32 v212, v188, v189
    v_cvt_pk_bf16_f32 v213, v190, v191
    s_waitcnt lgkmcnt(2)
    v_mfma_f32_32x32x16_bf16 v[140:155], v[88:91], v[220:223], v[140:155]
    ds_read_b128 v[80:83], v30 offset:5120
    buffer_load_dwordx4 v17, s[16:19], s72 offen offset:3072 lds
    v_exp_f32 v194, v114
    v_exp_f32 v195, v115
    v_exp_f32 v196, v116
    v_exp_f32 v197, v117
    v_exp_f32 v198, v118
    v_cvt_pk_bf16_f32 v214, v192, v193
    v_cvt_pk_bf16_f32 v215, v194, v195
    v_cvt_pk_bf16_f32 v216, v196, v197
    s_xor_b32 s72, s3, 0x30000
    s_add_u32 s72, s72, s95
    s_add_u32 m0, s69, 0x1e000
    s_waitcnt lgkmcnt(2)
    v_mfma_f32_32x32x16_bf16 v[140:155], v[92:95], v[224:227], v[140:155]
    ds_read_b128 v[84:87], v30 offset:6400
    buffer_load_dwordx4 v14, s[16:19], s72 offen offset:0 lds
    v_exp_f32 v199, v119
    v_exp_f32 v200, v120
    v_exp_f32 v201, v121
    v_exp_f32 v202, v122
    v_exp_f32 v203, v123
    v_cvt_pk_bf16_f32 v217, v198, v199
    v_cvt_pk_bf16_f32 v218, v200, v201
    v_cvt_pk_bf16_f32 v219, v202, v203
    s_waitcnt lgkmcnt(2)
    v_mfma_f32_32x32x16_bf16 v[108:123], v[72:75], v[204:207], 0
    ds_read_b128 v[76:79], v29 offset:10240
    buffer_load_dwordx4 v15, s[16:19], s72 offen offset:1024 lds
    v_exp_f32 v188, v124
    v_exp_f32 v189, v125
    v_exp_f32 v190, v126
    v_exp_f32 v191, v127
    v_exp_f32 v192, v128
    v_exp_f32 v193, v129
    v_cvt_pk_bf16_f32 v220, v188, v189
    v_cvt_pk_bf16_f32 v221, v190, v191
    s_waitcnt lgkmcnt(2)
    v_mfma_f32_32x32x16_bf16 v[140:155], v[80:83], v[212:215], v[140:155]
    ds_read_b128 v[88:91], v30 offset:7680
    buffer_load_dwordx4 v16, s[16:19], s72 offen offset:2048 lds
    v_exp_f32 v194, v130
    v_exp_f32 v195, v131
    v_exp_f32 v196, v132
    v_exp_f32 v197, v133
    v_exp_f32 v198, v134
    v_cvt_pk_bf16_f32 v222, v192, v193
    v_cvt_pk_bf16_f32 v223, v194, v195
    v_cvt_pk_bf16_f32 v224, v196, v197
    s_waitcnt lgkmcnt(2)
    v_mfma_f32_32x32x16_bf16 v[140:155], v[84:87], v[216:219], v[140:155]
    ds_read_b128 v[92:95], v30 offset:8960
    buffer_load_dwordx4 v17, s[16:19], s72 offen offset:3072 lds
    v_exp_f32 v199, v135
    v_exp_f32 v200, v136
    v_exp_f32 v201, v137
    v_exp_f32 v202, v138
    v_exp_f32 v203, v139
    v_cvt_pk_bf16_f32 v225, v198, v199
    v_cvt_pk_bf16_f32 v226, v200, v201
    v_cvt_pk_bf16_f32 v227, v202, v203
    s_xor_b32 s72, s3, 0x40000
    s_add_u32 s72, s72, s95
    s_add_u32 m0, s69, 0x14000
    s_waitcnt lgkmcnt(2)
    v_mfma_f32_32x32x16_bf16 v[124:139], v[76:79], v[204:207], 0
    ds_read_b128 v[72:75], v29 offset:12288
    buffer_load_dwordx4 v14, s[16:19], s72 offen offset:0 lds
    v_exp_f32 v188, v108
    v_exp_f32 v189, v109
    v_exp_f32 v190, v110
    v_exp_f32 v191, v111
    v_exp_f32 v192, v112
    v_exp_f32 v193, v113
    v_cvt_pk_bf16_f32 v212, v188, v189
    v_cvt_pk_bf16_f32 v213, v190, v191
    s_waitcnt lgkmcnt(2)
    v_mfma_f32_32x32x16_bf16 v[140:155], v[88:91], v[220:223], v[140:155]
    ds_read_b128 v[80:83], v30 offset:10240
    buffer_load_dwordx4 v15, s[16:19], s72 offen offset:1024 lds
    v_exp_f32 v194, v114
    v_exp_f32 v195, v115
    v_exp_f32 v196, v116
    v_exp_f32 v197, v117
    v_exp_f32 v198, v118
    v_cvt_pk_bf16_f32 v214, v192, v193
    v_cvt_pk_bf16_f32 v215, v194, v195
    v_cvt_pk_bf16_f32 v216, v196, v197
    s_waitcnt lgkmcnt(2)
    v_mfma_f32_32x32x16_bf16 v[140:155], v[92:95], v[224:227], v[140:155]
    ds_read_b128 v[84:87], v30 offset:11520
    buffer_load_dwordx4 v16, s[16:19], s72 offen offset:2048 lds
    s_load_dword s40, s[24:25], s85 glc
    v_exp_f32 v199, v119
    v_exp_f32 v200, v120
    v_exp_f32 v201, v121
    v_exp_f32 v202, v122
    v_exp_f32 v203, v123
    v_cvt_pk_bf16_f32 v217, v198, v199
    v_cvt_pk_bf16_f32 v218, v200, v201
    v_cvt_pk_bf16_f32 v219, v202, v203
    s_waitcnt lgkmcnt(2)
    v_mfma_f32_32x32x16_bf16 v[108:123], v[72:75], v[204:207], 0
    ds_read_b128 v[76:79], v29 offset:14336
    buffer_load_dwordx4 v17, s[16:19], s72 offen offset:3072 lds
    v_exp_f32 v188, v124
    v_exp_f32 v189, v125
    v_exp_f32 v190, v126
    v_exp_f32 v191, v127
    v_exp_f32 v192, v128
    v_exp_f32 v193, v129
    v_cvt_pk_bf16_f32 v220, v188, v189
    v_cvt_pk_bf16_f32 v221, v190, v191
    s_xor_b32 s72, s3, 0x50000
    s_add_u32 s72, s72, s95
    s_add_u32 m0, s69, 0x22000
    s_waitcnt lgkmcnt(2)
    v_mfma_f32_32x32x16_bf16 v[140:155], v[80:83], v[212:215], v[140:155]
    ds_read_b128 v[88:91], v30 offset:12800
    buffer_load_dwordx4 v14, s[16:19], s72 offen offset:0 lds
    v_exp_f32 v194, v130
    v_exp_f32 v195, v131
    v_exp_f32 v196, v132
    v_exp_f32 v197, v133
    v_exp_f32 v198, v134
    v_cvt_pk_bf16_f32 v222, v192, v193
    v_cvt_pk_bf16_f32 v223, v194, v195
    v_cvt_pk_bf16_f32 v224, v196, v197
    s_waitcnt lgkmcnt(2)
    v_mfma_f32_32x32x16_bf16 v[140:155], v[84:87], v[216:219], v[140:155]
    ds_read_b128 v[92:95], v30 offset:14080
    buffer_load_dwordx4 v15, s[16:19], s72 offen offset:1024 lds
    v_exp_f32 v199, v135
    v_exp_f32 v200, v136
    v_exp_f32 v201, v137
    v_exp_f32 v202, v138
    v_exp_f32 v203, v139
    v_cvt_pk_bf16_f32 v225, v198, v199
    v_cvt_pk_bf16_f32 v226, v200, v201
    v_cvt_pk_bf16_f32 v227, v202, v203
    s_waitcnt lgkmcnt(2)
    v_mfma_f32_32x32x16_bf16 v[124:139], v[76:79], v[204:207], 0
    ds_read_b128 v[72:75], v29 offset:16384
    buffer_load_dwordx4 v16, s[16:19], s72 offen offset:2048 lds
    v_exp_f32 v188, v108
    v_exp_f32 v189, v109
    v_exp_f32 v190, v110
    v_exp_f32 v191, v111
    v_exp_f32 v192, v112
    v_exp_f32 v193, v113
    v_cvt_pk_bf16_f32 v212, v188, v189
    v_cvt_pk_bf16_f32 v213, v190, v191
    s_waitcnt lgkmcnt(2)
    v_mfma_f32_32x32x16_bf16 v[140:155], v[88:91], v[220:223], v[140:155]
    ds_read_b128 v[80:83], v30 offset:15360
    buffer_load_dwordx4 v17, s[16:19], s72 offen offset:3072 lds
    v_exp_f32 v194, v114
    v_exp_f32 v195, v115
    v_exp_f32 v196, v116
    v_exp_f32 v197, v117
    v_exp_f32 v198, v118
    v_cvt_pk_bf16_f32 v214, v192, v193
    v_cvt_pk_bf16_f32 v215, v194, v195
    v_cvt_pk_bf16_f32 v216, v196, v197
    s_waitcnt lgkmcnt(2)
    v_mfma_f32_32x32x16_bf16 v[140:155], v[92:95], v[224:227], v[140:155]
    ds_read_b128 v[84:87], v30 offset:16640
    v_exp_f32 v199, v119
    v_exp_f32 v200, v120
    v_exp_f32 v201, v121
    v_exp_f32 v202, v122
    v_exp_f32 v203, v123
    v_cvt_pk_bf16_f32 v217, v198, v199
    v_cvt_pk_bf16_f32 v218, v200, v201
    v_cvt_pk_bf16_f32 v219, v202, v203
    s_waitcnt lgkmcnt(2)
    v_mfma_f32_32x32x16_bf16 v[108:123], v[72:75], v[204:207], v[40:55]
Lp_h3:
    s_waitcnt lgkmcnt(0)
    s_cmp_eq_u32 s40, 16
    s_cbranch_scc0 Lr_h3
Ld_h3:
    ds_read_b128 v[76:79], v29 offset:1024
    v_exp_f32 v188, v124
    v_exp_f32 v189, v125
    v_exp_f32 v190, v126
    s_add_u32 s73, s1, s80
    buffer_load_dwordx4 a[0:3], v10, s[24:27], s73 offen offset:0 sc1
    v_exp_f32 v191, v127
    v_exp_f32 v192, v128
    v_exp_f32 v193, v129
    v_cvt_pk_bf16_f32 v220, v188, v189
    v_cvt_pk_bf16_f32 v221, v190, v191
    v_mfma_f32_32x32x16_bf16 v[140:155], v[80:83], v[212:215], v[140:155]
    ds_read_b128 v[88:91], v30 offset:17920
    buffer_load_dwordx4 a[4:7], v11, s[24:27], s73 offen offset:0 sc1
    v_exp_f32 v194, v130
    v_exp_f32 v195, v131
    v_exp_f32 v196, v132
    v_exp_f32 v197, v133
    v_exp_f32 v198, v134
    v_cvt_pk_bf16_f32 v222, v192, v193
    v_cvt_pk_bf16_f32 v223, v194, v195
    v_cvt_pk_bf16_f32 v224, v196, v197
    v_mfma_f32_32x32x16_bf16 v[140:155], v[84:87], v[216:219], v[140:155]
    ds_read_b128 v[92:95], v30 offset:19200
    buffer_load_dwordx4 a[8:11], v10, s[24:27], s73 offen offset:2048 sc1
    v_exp_f32 v199, v135
    v_exp_f32 v200, v136
    v_exp_f32 v201, v137
    v_exp_f32 v202, v138
    v_exp_f32 v203, v139
    v_cvt_pk_bf16_f32 v225, v198, v199
    v_cvt_pk_bf16_f32 v226, v200, v201
    v_cvt_pk_bf16_f32 v227, v202, v203
    s_waitcnt lgkmcnt(1)
    v_mfma_f32_32x32x16_bf16 v[124:139], v[76:79], v[208:211], v[56:71]
Lt_2:
    s_cbranch_execz Lt_3
    ds_read_b128 v[72:75], v29 offset:3072
    buffer_load_dwordx4 a[12:15], v11, s[24:27], s73 offen offset:2048 sc1
    v_exp_f32 v188, v108
    v_exp_f32 v189, v109
    v_exp_f32 v190, v110
    s_xor_b32 s73, s1, 0x1000
    s_add_u32 s73, s73, s80
    buffer_load_dwordx4 a[16:19], v10, s[24:27], s73 offen offset:0 sc1
    v_exp_f32 v191, v111
    v_exp_f32 v192, v112
    v_exp_f32 v193, v113
    v_cvt_pk_bf16_f32 v212, v188, v189
    v_cvt_pk_bf16_f32 v213, v190, v191
    v_mfma_f32_32x32x16_bf16 v[140:155], v[88:91], v[220:223], v[140:155]
    ds_read_b128 v[80:83], v30 offset:20480
    buffer_load_dwordx4 a[20:23], v11, s[24:27], s73 offen offset:0 sc1
    v_exp_f32 v194, v114
    v_exp_f32 v195, v115
    v_exp_f32 v196, v116
    v_exp_f32 v197, v117
    v_exp_f32 v198, v118
    v_cvt_pk_bf16_f32 v214, v192, v193
    v_cvt_pk_bf16_f32 v215, v194, v195
    v_cvt_pk_bf16_f32 v216, v196, v197
    s_waitcnt lgkmcnt(1)
    v_mfma_f32_32x32x16_bf16 v[140:155], v[92:95], v[224:227], v[140:155]
    ds_read_b128 v[84:87], v30 offset:21760
    buffer_load_dwordx4 a[24:27], v10, s[24:27], s73 offen offset:2048 sc1
    v_exp_f32 v199, v119
    v_exp_f32 v200, v120
    v_exp_f32 v201, v121
    v_exp_f32 v202, v122
    v_exp_f32 v203, v123
    v_cvt_pk_bf16_f32 v217, v198, v199
    v_cvt_pk_bf16_f32 v218, v200, v201
    v_cvt_pk_bf16_f32 v219, v202, v203
    v_mfma_f32_32x32x16_bf16 v[108:123], v[72:75], v[208:211], 0
    ds_read_b128 v[76:79], v29 offset:5120
    buffer_load_dwordx4 a[28:31], v11, s[24:27], s73 offen offset:2048 sc1
    v_exp_f32 v188, v124
    v_exp_f32 v189, v125
    v_exp_f32 v190, v126
    s_xor_b32 s73, s1, 0x2000
    s_add_u32 s73, s73, s80
    buffer_load_dwordx4 a[32:35], v10, s[24:27], s73 offen offset:0 sc1
    v_exp_f32 v191, v127
    v_exp_f32 v192, v128
    v_exp_f32 v193, v129
    v_cvt_pk_bf16_f32 v220, v188, v189
    v_cvt_pk_bf16_f32 v221, v190, v191
    s_waitcnt lgkmcnt(1)
    v_mfma_f32_32x32x16_bf16 v[140:155], v[80:83], v[212:215], v[140:155]
    ds_read_b128 v[88:91], v31 offset:0
    buffer_load_dwordx4 a[36:39], v11, s[24:27], s73 offen offset:0 sc1
    v_exp_f32 v194, v130
    v_exp_f32 v195, v131
    v_exp_f32 v196, v132
    v_exp_f32 v197, v133
    v_exp_f32 v198, v134
    v_cvt_pk_bf16_f32 v222, v192, v193
    v_cvt_pk_bf16_f32 v223, v194, v195
    v_cvt_pk_bf16_f32 v224, v196, v197
    v_mfma_f32_32x32x16_bf16 v[140:155], v[84:87], v[216:219], v[140:155]
    ds_read_b128 v[92:95], v31 offset:1280
    buffer_load_dwordx4 a[40:43], v10, s[24:27], s73 offen offset:2048 sc1
    v_exp_f32 v199, v135
    v_exp_f32 v200, v136
    v_exp_f32 v201, v137
    v_exp_f32 v202, v138
    v_exp_f32 v203, v139
    v_cvt_pk_bf16_f32 v225, v198, v199
    v_cvt_pk_bf16_f32 v226, v200, v201
    v_cvt_pk_bf16_f32 v227, v202, v203
    s_waitcnt lgkmcnt(1)
    v_mfma_f32_32x32x16_bf16 v[124:139], v[76:79], v[208:211], 0
    ds_read_b128 v[72:75], v29 offset:7168
    buffer_load_dwordx4 a[44:47], v11, s[24:27], s73 offen offset:2048 sc1
    v_exp_f32 v188, v108
    v_exp_f32 v189, v109
    v_exp_f32 v190, v110
    s_xor_b32 s73, s1, 0x3000
    s_add_u32 s73, s73, s80
    buffer_load_dwordx4 a[48:51], v10, s[24:27], s73 offen offset:0 sc1
    v_exp_f32 v191, v111
    v_exp_f32 v192, v112
    v_exp_f32 v193, v113
    v_cvt_pk_bf16_f32 v212, v188, v189
    v_cvt_pk_bf16_f32 v213, v190, v191
    v_mfma_f32_32x32x16_bf16 v[156:171], v[88:91], v[220:223], 0
    ds_read_b128 v[80:83], v31 offset:2560
    buffer_load_dwordx4 a[52:55], v11, s[24:27], s73 offen offset:0 sc1
    v_exp_f32 v194, v114
    v_exp_f32 v195, v115
    v_exp_f32 v196, v116
    v_exp_f32 v197, v117
    v_exp_f32 v198, v118
    v_cvt_pk_bf16_f32 v214, v192, v193
    v_cvt_pk_bf16_f32 v215, v194, v195
    v_cvt_pk_bf16_f32 v216, v196, v197
    s_waitcnt lgkmcnt(1)
    v_mfma_f32_32x32x16_bf16 v[156:171], v[92:95], v[224:227], v[156:171]
    ds_read_b128 v[84:87], v31 offset:3840
    buffer_load_dwordx4 a[56:59], v10, s[24:27], s73 offen offset:2048 sc1
    v_exp_f32 v199, v119
    v_exp_f32 v200, v120
    v_exp_f32 v201, v121
    v_exp_f32 v202, v122
    v_exp_f32 v203, v123
    v_cvt_pk_bf16_f32 v217, v198, v199
    v_cvt_pk_bf16_f32 v218, v200, v201
    v_cvt_pk_bf16_f32 v219, v202, v203
    v_mfma_f32_32x32x16_bf16 v[108:123], v[72:75], v[208:211], 0
    ds_read_b128 v[76:79], v29 offset:9216
    buffer_load_dwordx4 a[60:63], v11, s[24:27], s73 offen offset:2048 sc1
    v_exp_f32 v188, v124
    v_exp_f32 v189, v125
    v_exp_f32 v190, v126
    v_exp_f32 v191, v127
    v_exp_f32 v192, v128
    v_exp_f32 v193, v129
    v_rcp_f32 v230, v148
    s_nop 0
    v_mul_f32 v140, v140, v230
    v_mul_f32 v141, v141, v230
    v_cvt_pk_bf16_f32 v220, v188, v189
    v_cvt_pk_bf16_f32 v221, v190, v191
    s_xor_b32 s73, s1, 0x4000
    s_add_u32 s73, s73, s80
    s_waitcnt lgkmcnt(1)
    v_mfma_f32_32x32x16_bf16 v[156:171], v[80:83], v[212:215], v[156:171]
    ds_read_b128 v[88:91], v31 offset:5120
    buffer_load_dwordx4 a[64:67], v10, s[24:27], s73 offen offset:0 sc1
    v_exp_f32 v194, v130
    v_exp_f32 v195, v131
    v_exp_f32 v196, v132
    v_exp_f32 v197, v133
    v_exp_f32 v198, v134
    v_mul_f32 v142, v142, v230
    v_mul_f32 v143, v143, v230
    v_mul_f32 v144, v144, v230
    v_cvt_pk_bf16_f32 v222, v192, v193
    v_cvt_pk_bf16_f32 v223, v194, v195
    v_cvt_pk_bf16_f32 v224, v196, v197
    v_mfma_f32_32x32x16_bf16 v[156:171], v[84:87], v[216:219], v[156:171]
    ds_read_b128 v[92:95], v31 offset:6400
    buffer_load_dwordx4 a[68:71], v11, s[24:27], s73 offen offset:0 sc1
    v_exp_f32 v199, v135
    v_exp_f32 v200, v136
    v_exp_f32 v201, v137
    v_exp_f32 v202, v138
    v_exp_f32 v203, v139
    v_mul_f32 v145, v145, v230
    v_mul_f32 v146, v146, v230
    v_mul_f32 v147, v147, v230
    v_cvt_pk_bf16_f32 v225, v198, v199
    v_cvt_pk_bf16_f32 v226, v200, v201
    v_cvt_pk_bf16_f32 v227, v202, v203
    s_waitcnt lgkmcnt(1)
    v_mfma_f32_32x32x16_bf16 v[124:139], v[76:79], v[208:211], 0
    ds_read_b128 v[72:75], v29 offset:11264
    buffer_load_dwordx4 a[72:75], v10, s[24:27], s73 offen offset:2048 sc1
    v_exp_f32 v188, v108
    v_exp_f32 v189, v109
    v_exp_f32 v190, v110
    buffer_load_dwordx4 a[76:79], v11, s[24:27], s73 offen offset:2048 sc1
    v_exp_f32 v191, v111
    v_exp_f32 v192, v112
    v_exp_f32 v193, v113
    v_cvt_pk_bf16_f32 v232, v140, v141
    v_cvt_pk_bf16_f32 v233, v142, v143
    v_cvt_pk_bf16_f32 v234, v144, v145
    v_cvt_pk_bf16_f32 v212, v188, v189
    v_cvt_pk_bf16_f32 v213, v190, v191
    s_xor_b32 s73, s1, 0x5000
    s_add_u32 s73, s73, s80
    v_mfma_f32_32x32x16_bf16 v[156:171], v[88:91], v[220:223], v[156:171]
    ds_read_b128 v[80:83], v31 offset:7680
    buffer_load_dwordx4 a[80:83], v10, s[24:27], s73 offen offset:0 sc1
    v_exp_f32 v194, v114
    v_exp_f32 v195, v115
    v_exp_f32 v196, v116
    v_exp_f32 v197, v117
    v_exp_f32 v198, v118
    v_cvt_pk_bf16_f32 v235, v146, v147
    v_cvt_pk_bf16_f32 v214, v192, v193
    v_cvt_pk_bf16_f32 v215, v194, v195
    v_cvt_pk_bf16_f32 v216, v196, v197
    s_waitcnt lgkmcnt(1)
    v_mfma_f32_32x32x16_bf16 v[156:171], v[92:95], v[224:227], v[156:171]
    ds_read_b128 v[84:87], v31 offset:8960
    buffer_load_dwordx4 a[84:87], v11, s[24:27], s73 offen offset:0 sc1
    v_exp_f32 v199, v119
    v_exp_f32 v200, v120
    v_exp_f32 v201, v121
    v_exp_f32 v202, v122
    v_exp_f32 v203, v123
    v_cvt_pk_bf16_f32 v217, v198, v199
    v_cvt_pk_bf16_f32 v218, v200, v201
    v_cvt_pk_bf16_f32 v219, v202, v203
    v_mfma_f32_32x32x16_bf16 v[108:123], v[72:75], v[208:211], 0
    ds_read_b128 v[76:79], v29 offset:13312
    buffer_load_dwordx4 a[88:91], v10, s[24:27], s73 offen offset:2048 sc1
    v_exp_f32 v188, v124
    v_exp_f32 v189, v125
    v_exp_f32 v190, v126
    buffer_load_dwordx4 a[92:95], v11, s[24:27], s73 offen offset:2048 sc1
    v_exp_f32 v191, v127
    v_exp_f32 v192, v128
    v_exp_f32 v193, v129
    v_cvt_pk_bf16_f32 v220, v188, v189
    v_cvt_pk_bf16_f32 v221, v190, v191
    s_waitcnt lgkmcnt(1)
    v_mfma_f32_32x32x16_bf16 v[156:171], v[80:83], v[212:215], v[156:171]
    ds_read_b128 v[88:91], v31 offset:10240
    v_exp_f32 v194, v130
    v_exp_f32 v195, v131
    v_exp_f32 v196, v132
    v_exp_f32 v197, v133
    v_exp_f32 v198, v134
    v_cvt_pk_bf16_f32 v222, v192, v193
    v_cvt_pk_bf16_f32 v223, v194, v195
    v_cvt_pk_bf16_f32 v224, v196, v197
    s_xor_b32 s73, s1, 0x6000
    s_add_u32 s73, s73, s80
    v_mfma_f32_32x32x16_bf16 v[156:171], v[84:87], v[216:219], v[156:171]
    ds_read_b128 v[92:95], v31 offset:11520
    buffer_load_dwordx4 a[96:99], v10, s[24:27], s73 offen offset:0 sc1
    v_exp_f32 v199, v135
    v_exp_f32 v200, v136
    v_exp_f32 v201, v137
    v_exp_f32 v202, v138
    v_exp_f32 v203, v139
    v_cvt_pk_bf16_f32 v225, v198, v199
    v_cvt_pk_bf16_f32 v226, v200, v201
    v_cvt_pk_bf16_f32 v227, v202, v203
    s_waitcnt lgkmcnt(1)
    v_mfma_f32_32x32x16_bf16 v[124:139], v[76:79], v[208:211], 0
    ds_read_b128 v[72:75], v29 offset:15360
    buffer_load_dwordx4 a[100:103], v11, s[24:27], s73 offen offset:0 sc1
    v_exp_f32 v188, v108
    v_exp_f32 v189, v109
    v_exp_f32 v190, v110
    buffer_load_dwordx4 a[104:107], v10, s[24:27], s73 offen offset:2048 sc1
    v_exp_f32 v191, v111
    v_exp_f32 v192, v112
    v_exp_f32 v193, v113
    v_cvt_pk_bf16_f32 v212, v188, v189
    v_cvt_pk_bf16_f32 v213, v190, v191
    v_mfma_f32_32x32x16_bf16 v[156:171], v[88:91], v[220:223], v[156:171]
    ds_read_b128 v[80:83], v31 offset:12800
    v_exp_f32 v194, v114
    v_exp_f32 v195, v115
    v_exp_f32 v196, v116
    v_exp_f32 v197, v117
    v_exp_f32 v198, v118
    v_cvt_pk_bf16_f32 v214, v192, v193
    v_cvt_pk_bf16_f32 v215, v194, v195
    v_cvt_pk_bf16_f32 v216, v196, v197
    s_waitcnt lgkmcnt(1)
    v_mfma_f32_32x32x16_bf16 v[156:171], v[92:95], v[224:227], v[156:171]
    ds_read_b128 v[84:87], v31 offset:14080
    buffer_load_dwordx4 a[108:111], v11, s[24:27], s73 offen offset:2048 sc1
    v_exp_f32 v199, v119
    v_exp_f32 v200, v120
    v_exp_f32 v201, v121
    v_exp_f32 v202, v122
    v_exp_f32 v203, v123
    v_cvt_pk_bf16_f32 v217, v198, v199
    v_cvt_pk_bf16_f32 v218, v200, v201
    v_cvt_pk_bf16_f32 v219, v202, v203
    s_xor_b32 s73, s1, 0x7000
    s_add_u32 s73, s73, s80
    v_mfma_f32_32x32x16_bf16 v[108:123], v[72:75], v[208:211], 0
    ds_read_b128 v[76:79], v29 offset:17408
    buffer_load_dwordx4 a[112:115], v10, s[24:27], s73 offen offset:0 sc1
    v_exp_f32 v188, v124
    v_exp_f32 v189, v125
    v_exp_f32 v190, v126
    buffer_load_dwordx4 a[116:119], v11, s[24:27], s73 offen offset:0 sc1
    v_exp_f32 v191, v127
    v_exp_f32 v192, v128
    v_exp_f32 v193, v129
    v_cvt_pk_bf16_f32 v220, v188, v189
    v_cvt_pk_bf16_f32 v221, v190, v191
    s_waitcnt lgkmcnt(1)
    v_mfma_f32_32x32x16_bf16 v[156:171], v[80:83], v[212:215], v[156:171]
    ds_read_b128 v[88:91], v31 offset:15360
    buffer_load_dwordx4 a[120:123], v10, s[24:27], s73 offen offset:2048 sc1
    v_exp_f32 v194, v130
    v_exp_f32 v195, v131
    v_exp_f32 v196, v132
    v_exp_f32 v197, v133
    v_exp_f32 v198, v134
    v_cvt_pk_bf16_f32 v222, v192, v193
    v_cvt_pk_bf16_f32 v223, v194, v195
    v_cvt_pk_bf16_f32 v224, v196, v197
    v_mfma_f32_32x32x16_bf16 v[156:171], v[84:87], v[216:219], v[156:171]
    ds_read_b128 v[92:95], v31 offset:16640
    buffer_load_dwordx4 a[124:127], v11, s[24:27], s73 offen offset:2048 sc1
    v_exp_f32 v199, v135
    v_exp_f32 v200, v136
    v_exp_f32 v201, v137
    v_exp_f32 v202, v138
    v_exp_f32 v203, v139
    v_cvt_pk_bf16_f32 v225, v198, v199
    v_cvt_pk_bf16_f32 v226, v200, v201
    v_cvt_pk_bf16_f32 v227, v202, v203
    s_add_u32 s73, s80, 0x8000
    s_waitcnt lgkmcnt(1)
    v_mfma_f32_32x32x16_bf16 v[124:139], v[76:79], v[208:211], v[40:55]
    buffer_load_dwordx4 a[128:131], v10, s[24:27], s73 offen offset:0 sc1
    v_exp_f32 v188, v108
    v_exp_f32 v189, v109
    v_exp_f32 v190, v110
    buffer_load_dwordx4 a[132:135], v11, s[24:27], s73 offen offset:0 sc1
    v_exp_f32 v191, v111
    v_exp_f32 v192, v112
    v_exp_f32 v193, v113
    v_cvt_pk_bf16_f32 v212, v188, v189
    v_cvt_pk_bf16_f32 v213, v190, v191
    v_mfma_f32_32x32x16_bf16 v[156:171], v[88:91], v[220:223], v[156:171]
    ds_read_b128 v[80:83], v31 offset:17920
    v_exp_f32 v194, v114
    v_exp_f32 v195, v115
    v_exp_f32 v196, v116
    v_exp_f32 v197, v117
    v_exp_f32 v198, v118
    v_cvt_pk_bf16_f32 v214, v192, v193
    v_cvt_pk_bf16_f32 v215, v194, v195
    v_cvt_pk_bf16_f32 v216, v196, v197
    s_waitcnt lgkmcnt(1)
    v_mfma_f32_32x32x16_bf16 v[156:171], v[92:95], v[224:227], v[156:171]
    ds_read_b128 v[84:87], v31 offset:19200
    buffer_load_dwordx4 a[136:139], v10, s[24:27], s73 offen offset:2048 sc1
    v_exp_f32 v199, v119
    v_exp_f32 v200, v120
    v_exp_f32 v201, v121
    v_exp_f32 v202, v122
    v_exp_f32 v203, v123
    v_cvt_pk_bf16_f32 v217, v198, v199
    v_cvt_pk_bf16_f32 v218, v200, v201
    v_cvt_pk_bf16_f32 v219, v202, v203
    buffer_load_dwordx4 a[140:143], v11, s[24:27], s73 offen offset:2048 sc1
    v_exp_f32 v188, v124
    v_exp_f32 v189, v125
    v_exp_f32 v190, v126
    s_add_u32 s73, s80, 0x9000
    buffer_load_dwordx4 a[144:147], v10, s[24:27], s73 offen offset:0 sc1
    v_exp_f32 v191, v127
    v_exp_f32 v192, v128
    v_exp_f32 v193, v129
    v_cvt_pk_bf16_f32 v220, v188, v189
    v_cvt_pk_bf16_f32 v221, v190, v191
    s_waitcnt lgkmcnt(0)
    v_mfma_f32_32x32x16_bf16 v[156:171], v[80:83], v[212:215], v[156:171]
    ds_read_b128 v[88:91], v31 offset:20480
    buffer_load_dwordx4 a[148:151], v11, s[24:27], s73 offen offset:0 sc1
    v_exp_f32 v194, v130
    v_exp_f32 v195, v131
    v_exp_f32 v196, v132
    v_exp_f32 v197, v133
    v_exp_f32 v198, v134
    v_cvt_pk_bf16_f32 v222, v192, v193
    v_cvt_pk_bf16_f32 v223, v194, v195
    v_cvt_pk_bf16_f32 v224, v196, v197
    v_mfma_f32_32x32x16_bf16 v[156:171], v[84:87], v[216:219], v[156:171]
    ds_read_b128 v[92:95], v31 offset:21760
    buffer_store_dwordx4 v[232:235], v8, s[24:27], s79 offen offset:0 sc1
    v_exp_f32 v199, v135
    v_exp_f32 v200, v136
    v_exp_f32 v201, v137
    v_exp_f32 v202, v138
    v_exp_f32 v203, v139
    v_cvt_pk_bf16_f32 v225, v198, v199
    v_cvt_pk_bf16_f32 v226, v200, v201
    v_cvt_pk_bf16_f32 v227, v202, v203
    s_waitcnt lgkmcnt(1)
    v_mfma_f32_32x32x16_bf16 v[156:171], v[88:91], v[220:223], v[156:171]
    s_waitcnt lgkmcnt(0)
    v_mfma_f32_32x32x16_bf16 v[156:171], v[92:95], v[224:227], v[156:171]
L_join:
    s_waitcnt vmcnt(26)
    s_barrier
    ds_read_b64_tr_b16 v[72:73], v32 offset:32768
    ds_read_b64_tr_b16 v[74:75], v32 offset:36864
    ds_read_b64_tr_b16 v[76:77], v33 offset:32768
    ds_read_b64_tr_b16 v[78:79], v33 offset:36864
    ds_read_b64_tr_b16 v[80:81], v18 offset:32768
    ds_read_b64_tr_b16 v[82:83], v18 offset:36864
    ds_read_b64_tr_b16 v[84:85], v19 offset:32768
    ds_read_b64_tr_b16 v[86:87], v19 offset:36864
    ds_read_b64_tr_b16 v[88:89], v32 offset:34816
    ds_read_b64_tr_b16 v[90:91], v32 offset:38912
    ds_read_b64_tr_b16 v[92:93], v33 offset:34816
    ds_read_b64_tr_b16 v[94:95], v33 offset:38912
    v_rcp_f32 v230, v164
    s_nop 0
    v_mul_f32 v156, v156, v230
    v_mul_f32 v157, v157, v230
    v_mul_f32 v158, v158, v230
    v_mul_f32 v159, v159, v230
    v_mul_f32 v160, v160, v230
    v_mul_f32 v161, v161, v230
    v_mul_f32 v162, v162, v230
    v_mul_f32 v163, v163, v230
    v_cvt_pk_bf16_f32 v236, v156, v157
    v_cvt_pk_bf16_f32 v237, v158, v159
    v_cvt_pk_bf16_f32 v238, v160, v161
    v_cvt_pk_bf16_f32 v239, v162, v163
    buffer_store_dwordx4 v[236:239], v8, s[24:27], s79 offen offset:512 sc1
    s_xor_b32 s72, s3, 0x60000
    s_add_u32 s72, s72, s95
    s_add_u32 m0, s69, 0x0
    s_waitcnt lgkmcnt(9)
    v_mfma_f32_16x16x32_bf16 v[40:43], v[72:75], a[0:3], 0
    buffer_load_dwordx4 v14, s[16:19], s72 offen offset:0 lds
    v_mfma_f32_16x16x32_bf16 v[44:47], v[72:75], a[4:7], 0
    ds_read_b64_tr_b16 v[96:97], v18 offset:34816
    ds_read_b64_tr_b16 v[98:99], v18 offset:38912
    s_waitcnt lgkmcnt(2)
    v_mfma_f32_16x16x32_bf16 v[48:51], v[76:79], a[0:3], 0
    buffer_load_dwordx4 v15, s[16:19], s72 offen offset:1024 lds
    v_mfma_f32_16x16x32_bf16 v[52:55], v[76:79], a[4:7], 0
    ds_read_b64_tr_b16 v[100:101], v19 offset:34816
    ds_read_b64_tr_b16 v[102:103], v19 offset:38912
    v_mfma_f32_16x16x32_bf16 v[56:59], v[80:83], a[0:3], 0
    buffer_load_dwordx4 v16, s[16:19], s72 offen offset:2048 lds
    v_mfma_f32_16x16x32_bf16 v[60:63], v[80:83], a[4:7], 0
    s_barrier
    ds_read_b64_tr_b16 v[104:105], v32 offset:49152
    ds_read_b64_tr_b16 v[106:107], v32 offset:53248
    v_mfma_f32_16x16x32_bf16 v[64:67], v[84:87], a[0:3], 0
    buffer_load_dwordx4 v17, s[16:19], s72 offen offset:3072 lds
    v_mfma_f32_16x16x32_bf16 v[68:71], v[84:87], a[4:7], 0
    ds_read_b64_tr_b16 v[72:73], v33 offset:49152
    ds_read_b64_tr_b16 v[74:75], v33 offset:53248
    s_xor_b32 s72, s3, 0x70000
    s_add_u32 s72, s72, s95
    s_add_u32 m0, s69, 0x4000
    v_mfma_f32_16x16x32_bf16 v[40:43], v[88:91], a[8:11], v[40:43]
    buffer_load_dwordx4 v14, s[16:19], s72 offen offset:0 lds
    v_mfma_f32_16x16x32_bf16 v[44:47], v[88:91], a[12:15], v[44:47]
    ds_read_b64_tr_b16 v[76:77], v18 offset:49152
    ds_read_b64_tr_b16 v[78:79], v18 offset:53248
    v_mfma_f32_16x16x32_bf16 v[48:51], v[92:95], a[8:11], v[48:51]
    buffer_load_dwordx4 v15, s[16:19], s72 offen offset:1024 lds
    v_mfma_f32_16x16x32_bf16 v[52:55], v[92:95], a[12:15], v[52:55]
    ds_read_b64_tr_b16 v[80:81], v19 offset:49152
    ds_read_b64_tr_b16 v[82:83], v19 offset:53248
    s_waitcnt lgkmcnt(7)
    v_mfma_f32_16x16x32_bf16 v[56:59], v[96:99], a[8:11], v[56:59]
    ds_read_b64_tr_b16 v[84:85], v32 offset:51200
    v_mfma_f32_16x16x32_bf16 v[60:63], v[96:99], a[12:15], v[60:63]
    ds_read_b64_tr_b16 v[86:87], v32 offset:55296
    v_mfma_f32_16x16x32_bf16 v[64:67], v[100:103], a[8:11], v[64:67]
    ds_read_b64_tr_b16 v[88:89], v33 offset:51200
    v_mfma_f32_16x16x32_bf16 v[68:71], v[100:103], a[12:15], v[68:71]
    ds_read_b64_tr_b16 v[90:91], v33 offset:55296
    s_waitcnt lgkmcnt(8)
    v_mfma_f32_16x16x32_bf16 v[40:43], v[104:107], a[16:19], v[40:43]
    ds_read_b64_tr_b16 v[92:93], v18 offset:51200
    v_mfma_f32_16x16x32_bf16 v[44:47], v[104:107], a[20:23], v[44:47]
    ds_read_b64_tr_b16 v[94:95], v18 offset:55296
    v_mfma_f32_16x16x32_bf16 v[48:51], v[72:75], a[16:19], v[48:51]
    buffer_load_dwordx4 v16, s[16:19], s72 offen offset:2048 lds
    v_mfma_f32_16x16x32_bf16 v[52:55], v[72:75], a[20:23], v[52:55]
    ds_read_b64_tr_b16 v[96:97], v19 offset:51200
    ds_read_b64_tr_b16 v[98:99], v19 offset:55296
    s_waitcnt lgkmcnt(7)
    v_mfma_f32_16x16x32_bf16 v[56:59], v[76:79], a[16:19], v[56:59]
    s_barrier
    v_mfma_f32_16x16x32_bf16 v[60:63], v[76:79], a[20:23], v[60:63]
    ds_read_b64_tr_b16 v[100:101], v34 offset:0
    ds_read_b64_tr_b16 v[102:103], v34 offset:4096
    v_mfma_f32_16x16x32_bf16 v[64:67], v[80:83], a[16:19], v[64:67]
    buffer_load_dwordx4 v17, s[16:19], s72 offen offset:3072 lds
    v_mfma_f32_16x16x32_bf16 v[68:71], v[80:83], a[20:23], v[68:71]
    ds_read_b64_tr_b16 v[104:105], v35 offset:0
    ds_read_b64_tr_b16 v[106:107], v35 offset:4096
    s_waitcnt lgkmcnt(6)
    v_mfma_f32_16x16x32_bf16 v[40:43], v[84:87], a[24:27], v[40:43]
    ds_read_b64_tr_b16 v[72:73], v20 offset:0
    v_mfma_f32_16x16x32_bf16 v[44:47], v[84:87], a[28:31], v[44:47]
    ds_read_b64_tr_b16 v[74:75], v20 offset:4096
    v_mfma_f32_16x16x32_bf16 v[48:51], v[88:91], a[24:27], v[48:51]
    ds_read_b64_tr_b16 v[76:77], v21 offset:0
    v_mfma_f32_16x16x32_bf16 v[52:55], v[88:91], a[28:31], v[52:55]
    ds_read_b64_tr_b16 v[78:79], v21 offset:4096
    v_mfma_f32_16x16x32_bf16 v[56:59], v[92:95], a[24:27], v[56:59]
    ds_read_b64_tr_b16 v[80:81], v34 offset:2048
    v_mfma_f32_16x16x32_bf16 v[60:63], v[92:95], a[28:31], v[60:63]
    ds_read_b64_tr_b16 v[82:83], v34 offset:6144
    s_waitcnt lgkmcnt(8)
    v_mfma_f32_16x16x32_bf16 v[64:67], v[96:99], a[24:27], v[64:67]
    ds_read_b64_tr_b16 v[84:85], v35 offset:2048
    v_mfma_f32_16x16x32_bf16 v[68:71], v[96:99], a[28:31], v[68:71]
    ds_read_b64_tr_b16 v[86:87], v35 offset:6144
    s_add_u32 s72, s95, 0x80000
    s_add_u32 m0, s69, 0x18000
    v_mfma_f32_16x16x32_bf16 v[40:43], v[100:103], a[32:35], v[40:43]
    buffer_load_dwordx4 v14, s[16:19], s72 offen offset:0 lds
    v_mfma_f32_16x16x32_bf16 v[44:47], v[100:103], a[36:39], v[44:47]
    ds_read_b64_tr_b16 v[88:89], v20 offset:2048
    ds_read_b64_tr_b16 v[90:91], v20 offset:6144
    s_waitcnt lgkmcnt(7)
    v_mfma_f32_16x16x32_bf16 v[48:51], v[104:107], a[32:35], v[48:51]
    ds_read_b64_tr_b16 v[92:93], v21 offset:2048
    v_mfma_f32_16x16x32_bf16 v[52:55], v[104:107], a[36:39], v[52:55]
    ds_read_b64_tr_b16 v[94:95], v21 offset:6144
    v_mfma_f32_16x16x32_bf16 v[56:59], v[72:75], a[32:35], v[56:59]
    s_barrier
    v_mfma_f32_16x16x32_bf16 v[60:63], v[72:75], a[36:39], v[60:63]
    ds_read_b64_tr_b16 v[96:97], v34 offset:57344
    ds_read_b64_tr_b16 v[98:99], v34 offset:61440
    s_waitcnt lgkmcnt(6)
    v_mfma_f32_16x16x32_bf16 v[64:67], v[76:79], a[32:35], v[64:67]
    ds_read_b64_tr_b16 v[100:101], v35 offset:57344
    v_mfma_f32_16x16x32_bf16 v[68:71], v[76:79], a[36:39], v[68:71]
    ds_read_b64_tr_b16 v[102:103], v35 offset:61440
    v_mfma_f32_16x16x32_bf16 v[40:43], v[80:83], a[40:43], v[40:43]
    ds_read_b64_tr_b16 v[104:105], v20 offset:57344
    v_mfma_f32_16x16x32_bf16 v[44:47], v[80:83], a[44:47], v[44:47]
    ds_read_b64_tr_b16 v[106:107], v20 offset:61440
    v_mfma_f32_16x16x32_bf16 v[48:51], v[84:87], a[40:43], v[48:51]
    ds_read_b64_tr_b16 v[72:73], v21 offset:57344
    v_mfma_f32_16x16x32_bf16 v[52:55], v[84:87], a[44:47], v[52:55]
    ds_read_b64_tr_b16 v[74:75], v21 offset:61440
    s_waitcnt lgkmcnt(8)
    v_mfma_f32_16x16x32_bf16 v[56:59], v[88:91], a[40:43], v[56:59]
    v_mfma_f32_16x16x32_bf16 v[60:63], v[88:91], a[44:47], v[60:63]
    s_waitcnt vmcnt(9)
    s_atomic_add s86, s[24:25], s68 offset:4
    ds_read_b64_tr_b16 v[76:77], v34 offset:59392
    ds_read_b64_tr_b16 v[78:79], v34 offset:63488
    v_mfma_f32_16x16x32_bf16 v[64:67], v[92:95], a[40:43], v[64:67]
    buffer_load_dwordx4 v15, s[16:19], s72 offen offset:1024 lds
    v_mfma_f32_16x16x32_bf16 v[68:71], v[92:95], a[44:47], v[68:71]
    ds_read_b64_tr_b16 v[80:81], v35 offset:59392
    ds_read_b64_tr_b16 v[82:83], v35 offset:63488
    s_waitcnt lgkmcnt(10)
    v_mfma_f32_16x16x32_bf16 v[40:43], v[96:99], a[48:51], v[40:43]
    buffer_load_dwordx4 v16, s[16:19], s72 offen offset:2048 lds
    v_mfma_f32_16x16x32_bf16 v[44:47], v[96:99], a[52:55], v[44:47]
    ds_read_b64_tr_b16 v[84:85], v20 offset:59392
    ds_read_b64_tr_b16 v[86:87], v20 offset:63488
    s_waitcnt lgkmcnt(10)
    v_mfma_f32_16x16x32_bf16 v[48:51], v[100:103], a[48:51], v[48:51]
    buffer_load_dwordx4 v17, s[16:19], s72 offen offset:3072 lds
    v_mfma_f32_16x16x32_bf16 v[52:55], v[100:103], a[52:55], v[52:55]
    ds_read_b64_tr_b16 v[88:89], v21 offset:59392
    ds_read_b64_tr_b16 v[90:91], v21 offset:63488
    s_add_u32 s72, s95, 0x90000
    s_add_u32 m0, s69, 0x8000
    s_waitcnt lgkmcnt(10)
    v_mfma_f32_16x16x32_bf16 v[56:59], v[104:107], a[48:51], v[56:59]
    buffer_load_dwordx4 v14, s[16:19], s72 offen offset:0 lds
    v_mfma_f32_16x16x32_bf16 v[60:63], v[104:107], a[52:55], v[60:63]
    s_barrier
    ds_read_b64_tr_b16 v[92:93], v34 offset:16384
    ds_read_b64_tr_b16 v[94:95], v34 offset:20480
    s_waitcnt lgkmcnt(10)
    v_mfma_f32_16x16x32_bf16 v[64:67], v[72:75], a[48:51], v[64:67]
    buffer_load_dwordx4 v15, s[16:19], s72 offen offset:1024 lds
    v_mfma_f32_16x16x32_bf16 v[68:71], v[72:75], a[52:55], v[68:71]
    ds_read_b64_tr_b16 v[96:97], v35 offset:16384
    ds_read_b64_tr_b16 v[98:99], v35 offset:20480
    s_waitcnt lgkmcnt(10)
    v_mfma_f32_16x16x32_bf16 v[40:43], v[76:79], a[56:59], v[40:43]
    buffer_load_dwordx4 v16, s[16:19], s72 offen offset:2048 lds
    v_mfma_f32_16x16x32_bf16 v[44:47], v[76:79], a[60:63], v[44:47]
    ds_read_b64_tr_b16 v[100:101], v20 offset:16384
    ds_read_b64_tr_b16 v[102:103], v20 offset:20480
    s_waitcnt lgkmcnt(10)
    v_mfma_f32_16x16x32_bf16 v[48:51], v[80:83], a[56:59], v[48:51]
    buffer_load_dwordx4 v17, s[16:19], s72 offen offset:3072 lds
    v_mfma_f32_16x16x32_bf16 v[52:55], v[80:83], a[60:63], v[52:55]
    ds_read_b64_tr_b16 v[104:105], v21 offset:16384
    ds_read_b64_tr_b16 v[106:107], v21 offset:20480
    s_add_u32 s72, s95, 0xa0000
    s_add_u32 m0, s69, 0xc000
    s_waitcnt lgkmcnt(10)
    v_mfma_f32_16x16x32_bf16 v[56:59], v[84:87], a[56:59], v[56:59]
    buffer_load_dwordx4 v14, s[16:19], s72 offen offset:0 lds
    v_mfma_f32_16x16x32_bf16 v[60:63], v[84:87], a[60:63], v[60:63]
    ds_read_b64_tr_b16 v[72:73], v34 offset:18432
    ds_read_b64_tr_b16 v[74:75], v34 offset:22528
    s_waitcnt lgkmcnt(10)
    v_mfma_f32_16x16x32_bf16 v[64:67], v[88:91], a[56:59], v[64:67]
    ds_read_b64_tr_b16 v[76:77], v35 offset:18432
    v_mfma_f32_16x16x32_bf16 v[68:71], v[88:91], a[60:63], v[68:71]
    ds_read_b64_tr_b16 v[78:79], v35 offset:22528
    s_waitcnt lgkmcnt(10)
    v_mfma_f32_16x16x32_bf16 v[40:43], v[92:95], a[64:67], v[40:43]
    buffer_load_dwordx4 v15, s[16:19], s72 offen offset:1024 lds
    v_mfma_f32_16x16x32_bf16 v[44:47], v[92:95], a[68:71], v[44:47]
    ds_read_b64_tr_b16 v[80:81], v20 offset:18432
    ds_read_b64_tr_b16 v[82:83], v20 offset:22528
    s_waitcnt lgkmcnt(10)
    v_mfma_f32_16x16x32_bf16 v[48:51], v[96:99], a[64:67], v[48:51]
    ds_read_b64_tr_b16 v[84:85], v21 offset:18432
    v_mfma_f32_16x16x32_bf16 v[52:55], v[96:99], a[68:71], v[52:55]
    ds_read_b64_tr_b16 v[86:87], v21 offset:22528
    s_lshr_b32 s72, s96, 4
    s_add_u32 s72, s72, 1343488
    s_waitcnt lgkmcnt(10)
    v_mfma_f32_16x16x32_bf16 v[56:59], v[100:103], a[64:67], v[56:59]
    buffer_load_dwordx4 v16, s[16:19], s72 offen offset:2048 lds
    v_mfma_f32_16x16x32_bf16 v[60:63], v[100:103], a[68:71], v[60:63]
    s_barrier
    ds_read_b64_tr_b16 v[88:89], v36 offset:8192
    ds_read_b64_tr_b16 v[90:91], v36 offset:12288
    s_add_u32 s73, s80, 0x9000
    s_waitcnt lgkmcnt(10)
    v_mfma_f32_16x16x32_bf16 v[64:67], v[104:107], a[64:67], v[64:67]
    buffer_load_dwordx4 a[152:155], v10, s[24:27], s73 offen offset:2048 sc1
    v_mfma_f32_16x16x32_bf16 v[68:71], v[104:107], a[68:71], v[68:71]
    ds_read_b64_tr_b16 v[92:93], v37 offset:8192
    ds_read_b64_tr_b16 v[94:95], v37 offset:12288
    s_waitcnt lgkmcnt(10)
    v_mfma_f32_16x16x32_bf16 v[40:43], v[72:75], a[72:75], v[40:43]
    ds_read_b64_tr_b16 v[96:97], v22 offset:8192
    v_mfma_f32_16x16x32_bf16 v[44:47], v[72:75], a[76:79], v[44:47]
    ds_read_b64_tr_b16 v[98:99], v22 offset:12288
    s_waitcnt lgkmcnt(10)
    v_mfma_f32_16x16x32_bf16 v[48:51], v[76:79], a[72:75], v[48:51]
    buffer_load_dwordx4 a[156:159], v11, s[24:27], s73 offen offset:2048 sc1
    v_mfma_f32_16x16x32_bf16 v[52:55], v[76:79], a[76:79], v[52:55]
    ds_read_b64_tr_b16 v[100:101], v23 offset:8192
    ds_read_b64_tr_b16 v[102:103], v23 offset:12288
    s_waitcnt lgkmcnt(10)
    v_mfma_f32_16x16x32_bf16 v[56:59], v[80:83], a[72:75], v[56:59]
    ds_read_b64_tr_b16 v[104:105], v36 offset:10240
Lt_3:
    s_cbranch_execz Lt_back
    v_mfma_f32_16x16x32_bf16 v[60:63], v[80:83], a[76:79], v[60:63]
    ds_read_b64_tr_b16 v[106:107], v36 offset:14336
    s_add_u32 s72, s96, 0x0
    s_add_u32 m0, s69, 0x10000
    s_waitcnt lgkmcnt(10)
    v_mfma_f32_16x16x32_bf16 v[64:67], v[84:87], a[72:75], v[64:67]
    buffer_load_dwordx4 v14, s[20:23], s72 offen offset:0 lds
    v_mfma_f32_16x16x32_bf16 v[68:71], v[84:87], a[76:79], v[68:71]
    ds_read_b64_tr_b16 v[72:73], v37 offset:10240
    ds_read_b64_tr_b16 v[74:75], v37 offset:14336
    s_waitcnt lgkmcnt(10)
    v_mfma_f32_16x16x32_bf16 v[40:43], v[88:91], a[80:83], v[40:43]
    ds_read_b64_tr_b16 v[76:77], v22 offset:10240
    v_mfma_f32_16x16x32_bf16 v[44:47], v[88:91], a[84:87], v[44:47]
    ds_read_b64_tr_b16 v[78:79], v22 offset:14336
    s_waitcnt lgkmcnt(10)
    v_mfma_f32_16x16x32_bf16 v[48:51], v[92:95], a[80:83], v[48:51]
    buffer_load_dwordx4 v15, s[20:23], s72 offen offset:1024 lds
    v_mfma_f32_16x16x32_bf16 v[52:55], v[92:95], a[84:87], v[52:55]
    ds_read_b64_tr_b16 v[80:81], v23 offset:10240
    ds_read_b64_tr_b16 v[82:83], v23 offset:14336
    s_waitcnt lgkmcnt(10)
    v_mfma_f32_16x16x32_bf16 v[56:59], v[96:99], a[80:83], v[56:59]
    s_waitcnt vmcnt(19)
    s_barrier
    v_mfma_f32_16x16x32_bf16 v[60:63], v[96:99], a[84:87], v[60:63]
    ds_read_b64_tr_b16 v[84:85], v32 offset:0
    ds_read_b64_tr_b16 v[86:87], v32 offset:4096
    s_waitcnt lgkmcnt(10)
    v_mfma_f32_16x16x32_bf16 v[64:67], v[100:103], a[80:83], v[64:67]
    ds_read_b64_tr_b16 v[88:89], v33 offset:0
    v_mfma_f32_16x16x32_bf16 v[68:71], v[100:103], a[84:87], v[68:71]
    ds_read_b64_tr_b16 v[90:91], v33 offset:4096
    s_waitcnt lgkmcnt(10)
    v_mfma_f32_16x16x32_bf16 v[40:43], v[104:107], a[88:91], v[40:43]
    buffer_load_dwordx4 v16, s[20:23], s72 offen offset:2048 lds
    v_mfma_f32_16x16x32_bf16 v[44:47], v[104:107], a[92:95], v[44:47]
    ds_read_b64_tr_b16 v[92:93], v18 offset:0
    ds_read_b64_tr_b16 v[94:95], v18 offset:4096
    s_waitcnt lgkmcnt(10)
    v_mfma_f32_16x16x32_bf16 v[48:51], v[72:75], a[88:91], v[48:51]
    ds_read_b64_tr_b16 v[96:97], v19 offset:0
    v_mfma_f32_16x16x32_bf16 v[52:55], v[72:75], a[92:95], v[52:55]
    ds_read_b64_tr_b16 v[98:99], v19 offset:4096
    s_waitcnt lgkmcnt(10)
    v_mfma_f32_16x16x32_bf16 v[56:59], v[76:79], a[88:91], v[56:59]
    buffer_load_dwordx4 v17, s[20:23], s72 offen offset:3072 lds
    v_mfma_f32_16x16x32_bf16 v[60:63], v[76:79], a[92:95], v[60:63]
    s_load_dword s40, s[24:25], s85 offset:4 glc
    ds_read_b64_tr_b16 v[100:101], v32 offset:2048
    ds_read_b64_tr_b16 v[102:103], v32 offset:6144
    s_waitcnt lgkmcnt(10)
    v_mfma_f32_16x16x32_bf16 v[64:67], v[80:83], a[88:91], v[64:67]
    ds_read_b64_tr_b16 v[104:105], v33 offset:2048
    v_mfma_f32_16x16x32_bf16 v[68:71], v[80:83], a[92:95], v[68:71]
    ds_read_b64_tr_b16 v[106:107], v33 offset:6144
    s_add_u32 s73, s80, 0xa000
    s_waitcnt lgkmcnt(10)
    v_mfma_f32_16x16x32_bf16 v[40:43], v[84:87], a[96:99], v[40:43]
    buffer_load_dwordx4 a[160:163], v10, s[24:27], s73 offen offset:0 sc1
    v_mfma_f32_16x16x32_bf16 v[44:47], v[84:87], a[100:103], v[44:47]
    ds_read_b64_tr_b16 v[72:73], v18 offset:2048
    ds_read_b64_tr_b16 v[74:75], v18 offset:6144
    s_waitcnt lgkmcnt(10)
    v_mfma_f32_16x16x32_bf16 v[48:51], v[88:91], a[96:99], v[48:51]
    ds_read_b64_tr_b16 v[76:77], v19 offset:2048
    v_mfma_f32_16x16x32_bf16 v[52:55], v[88:91], a[100:103], v[52:55]
    ds_read_b64_tr_b16 v[78:79], v19 offset:6144
    s_waitcnt lgkmcnt(10)
    v_mfma_f32_16x16x32_bf16 v[56:59], v[92:95], a[96:99], v[56:59]
    buffer_load_dwordx4 a[164:167], v11, s[24:27], s73 offen offset:0 sc1
    v_mfma_f32_16x16x32_bf16 v[60:63], v[92:95], a[100:103], v[60:63]
    s_waitcnt vmcnt(19)
    s_barrier
    ds_read_b64_tr_b16 v[80:81], v32 offset:16384
    ds_read_b64_tr_b16 v[82:83], v32 offset:20480
    s_waitcnt lgkmcnt(10)
    v_mfma_f32_16x16x32_bf16 v[64:67], v[96:99], a[96:99], v[64:67]
    buffer_load_dwordx4 v[252:255], v39, s[24:27], s88 offen sc1
    v_mfma_f32_16x16x32_bf16 v[68:71], v[96:99], a[100:103], v[68:71]
    ds_read_b64_tr_b16 v[84:85], v33 offset:16384
    ds_read_b64_tr_b16 v[86:87], v33 offset:20480
    s_waitcnt lgkmcnt(10)
    v_mfma_f32_16x16x32_bf16 v[40:43], v[100:103], a[104:107], v[40:43]
    ds_read_b64_tr_b16 v[88:89], v18 offset:16384
    v_mfma_f32_16x16x32_bf16 v[44:47], v[100:103], a[108:111], v[44:47]
    ds_read_b64_tr_b16 v[90:91], v18 offset:20480
    s_lshr_b32 s73, s96, 4
    s_sub_u32 s73, s81, s73
    s_sub_u32 s73, s73, 12288
    s_waitcnt lgkmcnt(10)
    v_mfma_f32_16x16x32_bf16 v[48:51], v[104:107], a[104:107], v[48:51]
    buffer_load_dwordx4 a[172:175], v11, s[24:27], s73 offen offset:0 sc1
    v_mfma_f32_16x16x32_bf16 v[52:55], v[104:107], a[108:111], v[52:55]
    ds_read_b64_tr_b16 v[92:93], v19 offset:16384
    ds_read_b64_tr_b16 v[94:95], v19 offset:20480
    s_waitcnt lgkmcnt(10)
    v_mfma_f32_16x16x32_bf16 v[56:59], v[72:75], a[104:107], v[56:59]
    ds_read_b64_tr_b16 v[96:97], v32 offset:18432
    v_mfma_f32_16x16x32_bf16 v[60:63], v[72:75], a[108:111], v[60:63]
    ds_read_b64_tr_b16 v[98:99], v32 offset:22528
    s_add_u32 s72, s96, 0x10000
    s_add_u32 m0, s69, 0x1e000
    s_waitcnt lgkmcnt(10)
    v_mfma_f32_16x16x32_bf16 v[64:67], v[76:79], a[104:107], v[64:67]
    buffer_load_dwordx4 v14, s[20:23], s72 offen offset:0 lds
    v_mfma_f32_16x16x32_bf16 v[68:71], v[76:79], a[108:111], v[68:71]
    ds_read_b64_tr_b16 v[100:101], v33 offset:18432
    ds_read_b64_tr_b16 v[102:103], v33 offset:22528
    s_waitcnt lgkmcnt(10)
    v_mfma_f32_16x16x32_bf16 v[40:43], v[80:83], a[112:115], v[40:43]
    ds_read_b64_tr_b16 v[104:105], v18 offset:18432
    v_mfma_f32_16x16x32_bf16 v[44:47], v[80:83], a[116:119], v[44:47]
    ds_read_b64_tr_b16 v[106:107], v18 offset:22528
    s_waitcnt lgkmcnt(10)
    v_mfma_f32_16x16x32_bf16 v[48:51], v[84:87], a[112:115], v[48:51]
    buffer_load_dwordx4 v15, s[20:23], s72 offen offset:1024 lds
    v_mfma_f32_16x16x32_bf16 v[52:55], v[84:87], a[116:119], v[52:55]
    ds_read_b64_tr_b16 v[72:73], v19 offset:18432
    ds_read_b64_tr_b16 v[74:75], v19 offset:22528
    s_waitcnt lgkmcnt(10)
    v_mfma_f32_16x16x32_bf16 v[56:59], v[88:91], a[112:115], v[56:59]
    s_waitcnt vmcnt(19)
    s_barrier
    v_mfma_f32_16x16x32_bf16 v[60:63], v[88:91], a[116:119], v[60:63]
    ds_read_b64_tr_b16 v[76:77], v34 offset:32768
    ds_read_b64_tr_b16 v[78:79], v34 offset:36864
    s_waitcnt lgkmcnt(10)
    v_mfma_f32_16x16x32_bf16 v[64:67], v[92:95], a[112:115], v[64:67]
    buffer_load_dwordx4 v16, s[20:23], s72 offen offset:2048 lds
    v_mfma_f32_16x16x32_bf16 v[68:71], v[92:95], a[116:119], v[68:71]
    ds_read_b64_tr_b16 v[80:81], v35 offset:32768
    ds_read_b64_tr_b16 v[82:83], v35 offset:36864
    s_waitcnt lgkmcnt(10)
    v_mfma_f32_16x16x32_bf16 v[40:43], v[96:99], a[120:123], v[40:43]
    buffer_load_dwordx4 v17, s[20:23], s72 offen offset:3072 lds
    v_mfma_f32_16x16x32_bf16 v[44:47], v[96:99], a[124:127], v[44:47]
    ds_read_b64_tr_b16 v[84:85], v20 offset:32768
    ds_read_b64_tr_b16 v[86:87], v20 offset:36864
    s_waitcnt lgkmcnt(10)
    v_mfma_f32_16x16x32_bf16 v[48:51], v[100:103], a[120:123], v[48:51]
    ds_read_b64_tr_b16 v[88:89], v21 offset:32768
    v_mfma_f32_16x16x32_bf16 v[52:55], v[100:103], a[124:127], v[52:55]
    ds_read_b64_tr_b16 v[90:91], v21 offset:36864
    s_waitcnt lgkmcnt(10)
    v_mfma_f32_16x16x32_bf16 v[56:59], v[104:107], a[120:123], v[56:59]
    ds_read_b64_tr_b16 v[92:93], v34 offset:34816
    v_mfma_f32_16x16x32_bf16 v[60:63], v[104:107], a[124:127], v[60:63]
    ds_read_b64_tr_b16 v[94:95], v34 offset:38912
    s_waitcnt lgkmcnt(10)
    v_mfma_f32_16x16x32_bf16 v[64:67], v[72:75], a[120:123], v[64:67]
    ds_read_b64_tr_b16 v[96:97], v35 offset:34816
    v_mfma_f32_16x16x32_bf16 v[68:71], v[72:75], a[124:127], v[68:71]
    ds_read_b64_tr_b16 v[98:99], v35 offset:38912
    s_add_u32 s72, s96, 0x20000
    s_add_u32 m0, s69, 0x14000
    s_waitcnt lgkmcnt(10)
    v_mfma_f32_16x16x32_bf16 v[40:43], v[76:79], a[128:131], v[40:43]
    buffer_load_dwordx4 v14, s[20:23], s72 offen offset:0 lds
    v_mfma_f32_16x16x32_bf16 v[44:47], v[76:79], a[132:135], v[44:47]
Lp_o4:
    s_waitcnt lgkmcnt(0)
    s_cmp_eq_u32 s40, 8
    s_cbranch_scc0 Lr_o4
Ld_o4:
    ds_read_b64_tr_b16 v[100:101], v20 offset:34816
    ds_read_b64_tr_b16 v[102:103], v20 offset:38912
    s_xor_b32 s73, s81, 0x0
    v_mfma_f32_16x16x32_bf16 v[48:51], v[80:83], a[128:131], v[48:51]
    buffer_load_dwordx4 a[176:179], v10, s[24:27], s73 offen offset:0 sc1
    v_mfma_f32_16x16x32_bf16 v[52:55], v[80:83], a[132:135], v[52:55]
    ds_read_b64_tr_b16 v[104:105], v21 offset:34816
    ds_read_b64_tr_b16 v[106:107], v21 offset:38912
    v_mfma_f32_16x16x32_bf16 v[56:59], v[84:87], a[128:131], v[56:59]
    buffer_load_dwordx4 a[180:183], v11, s[24:27], s73 offen offset:0 sc1
    v_mfma_f32_16x16x32_bf16 v[60:63], v[84:87], a[132:135], v[60:63]
    s_waitcnt vmcnt(20)
    s_barrier
    ds_read_b64_tr_b16 v[72:73], v32 offset:32768
    ds_read_b64_tr_b16 v[74:75], v32 offset:36864
    v_mfma_f32_16x16x32_bf16 v[64:67], v[88:91], a[128:131], v[64:67]
    buffer_load_dwordx4 a[184:187], v10, s[24:27], s73 offen offset:2048 sc1
    v_mfma_f32_16x16x32_bf16 v[68:71], v[88:91], a[132:135], v[68:71]
    ds_read_b64_tr_b16 v[76:77], v33 offset:32768
    ds_read_b64_tr_b16 v[78:79], v33 offset:36864
    v_mfma_f32_16x16x32_bf16 v[40:43], v[92:95], a[136:139], v[40:43]
    ds_read_b64_tr_b16 v[80:81], v18 offset:32768
    v_mfma_f32_16x16x32_bf16 v[44:47], v[92:95], a[140:143], v[44:47]
    ds_read_b64_tr_b16 v[82:83], v18 offset:36864
    v_mfma_f32_16x16x32_bf16 v[48:51], v[96:99], a[136:139], v[48:51]
    buffer_load_dwordx4 a[188:191], v11, s[24:27], s73 offen offset:2048 sc1
    v_mfma_f32_16x16x32_bf16 v[52:55], v[96:99], a[140:143], v[52:55]
    ds_read_b64_tr_b16 v[84:85], v19 offset:32768
    ds_read_b64_tr_b16 v[86:87], v19 offset:36864
    s_waitcnt lgkmcnt(8)
    v_mfma_f32_16x16x32_bf16 v[56:59], v[100:103], a[136:139], v[56:59]
    ds_read_b64_tr_b16 v[88:89], v32 offset:34816
    v_mfma_f32_16x16x32_bf16 v[60:63], v[100:103], a[140:143], v[60:63]
    ds_read_b64_tr_b16 v[90:91], v32 offset:38912
    s_xor_b32 s73, s81, 0x1000
    v_mfma_f32_16x16x32_bf16 v[64:67], v[104:107], a[136:139], v[64:67]
    buffer_load_dwordx4 a[192:195], v10, s[24:27], s73 offen offset:0 sc1
    v_mfma_f32_16x16x32_bf16 v[68:71], v[104:107], a[140:143], v[68:71]
    ds_read_b64_tr_b16 v[92:93], v33 offset:34816
    ds_read_b64_tr_b16 v[94:95], v33 offset:38912
    s_waitcnt lgkmcnt(7)
    v_mfma_f32_16x16x32_bf16 v[40:43], v[72:75], a[144:147], v[40:43]
    ds_read_b64_tr_b16 v[96:97], v18 offset:34816
    v_mfma_f32_16x16x32_bf16 v[44:47], v[72:75], a[148:151], v[44:47]
    ds_read_b64_tr_b16 v[98:99], v18 offset:38912
    v_mfma_f32_16x16x32_bf16 v[48:51], v[76:79], a[144:147], v[48:51]
    buffer_load_dwordx4 a[196:199], v11, s[24:27], s73 offen offset:0 sc1
    v_mfma_f32_16x16x32_bf16 v[52:55], v[76:79], a[148:151], v[52:55]
    ds_read_b64_tr_b16 v[100:101], v19 offset:34816
    ds_read_b64_tr_b16 v[102:103], v19 offset:38912
    s_waitcnt lgkmcnt(7)
    v_mfma_f32_16x16x32_bf16 v[56:59], v[80:83], a[144:147], v[56:59]
    s_waitcnt vmcnt(21)
    s_barrier
    v_mfma_f32_16x16x32_bf16 v[60:63], v[80:83], a[148:151], v[60:63]
    ds_read_b64_tr_b16 v[104:105], v32 offset:49152
    ds_read_b64_tr_b16 v[106:107], v32 offset:53248
    v_mfma_f32_16x16x32_bf16 v[64:67], v[84:87], a[144:147], v[64:67]
    buffer_load_dwordx4 a[200:203], v10, s[24:27], s73 offen offset:2048 sc1
    v_mfma_f32_16x16x32_bf16 v[68:71], v[84:87], a[148:151], v[68:71]
    ds_read_b64_tr_b16 v[72:73], v33 offset:49152
    ds_read_b64_tr_b16 v[74:75], v33 offset:53248
    s_waitcnt vmcnt(20) lgkmcnt(6)
    v_mfma_f32_16x16x32_bf16 v[40:43], v[88:91], a[152:155], v[40:43]
    ds_read_b64_tr_b16 v[76:77], v18 offset:49152
    v_mfma_f32_16x16x32_bf16 v[44:47], v[88:91], a[156:159], v[44:47]
    ds_read_b64_tr_b16 v[78:79], v18 offset:53248
    v_mfma_f32_16x16x32_bf16 v[48:51], v[92:95], a[152:155], v[48:51]
    buffer_load_dwordx4 a[204:207], v11, s[24:27], s73 offen offset:2048 sc1
    v_mfma_f32_16x16x32_bf16 v[52:55], v[92:95], a[156:159], v[52:55]
    ds_read_b64_tr_b16 v[80:81], v19 offset:49152
    ds_read_b64_tr_b16 v[82:83], v19 offset:53248
    v_mfma_f32_16x16x32_bf16 v[56:59], v[96:99], a[152:155], v[56:59]
    ds_read_b64_tr_b16 v[84:85], v24 offset:51200
    v_mfma_f32_16x16x32_bf16 v[60:63], v[96:99], a[156:159], v[60:63]
    ds_read_b64_tr_b16 v[86:87], v24 offset:55296
    s_waitcnt lgkmcnt(8)
    v_mfma_f32_16x16x32_bf16 v[64:67], v[100:103], a[152:155], v[64:67]
    buffer_load_dwordx4 v15, s[20:23], s72 offen offset:1024 lds
    v_mfma_f32_16x16x32_bf16 v[68:71], v[100:103], a[156:159], v[68:71]
    ds_read_b64_tr_b16 v[88:89], v7 offset:51200
    ds_read_b64_tr_b16 v[90:91], v7 offset:55296
    s_waitcnt vmcnt(16)
    v_mfma_f32_16x16x32_bf16 v[40:43], v[104:107], a[160:163], v[40:43]
    v_xor_b32 v13, 64, v24
    v_mfma_f32_16x16x32_bf16 v[44:47], v[104:107], a[164:167], v[44:47]
    v_xor_b32 v25, 64, v7
    ds_read_b64_tr_b16 v[92:93], v13 offset:51200
    ds_read_b64_tr_b16 v[94:95], v13 offset:55296
    s_waitcnt lgkmcnt(8)
    v_mfma_f32_16x16x32_bf16 v[48:51], v[72:75], a[160:163], v[48:51]
    ds_read_b64_tr_b16 v[96:97], v25 offset:51200
    v_mfma_f32_16x16x32_bf16 v[52:55], v[72:75], a[164:167], v[52:55]
    ds_read_b64_tr_b16 v[98:99], v25 offset:55296
    v_mfma_f32_16x16x32_bf16 v[56:59], v[76:79], a[160:163], v[56:59]
    buffer_load_dwordx4 v16, s[20:23], s72 offen offset:2048 lds
    v_mfma_f32_16x16x32_bf16 v[60:63], v[76:79], a[164:167], v[60:63]
    s_barrier
    ds_read_b64_tr_b16 v[100:101], v34 offset:0
    ds_read_b64_tr_b16 v[102:103], v34 offset:4096
    s_waitcnt lgkmcnt(6)
    v_mfma_f32_16x16x32_bf16 v[64:67], v[80:83], a[160:163], v[64:67]
    buffer_load_dwordx4 v17, s[20:23], s72 offen offset:3072 lds
    v_mfma_f32_16x16x32_bf16 v[68:71], v[80:83], a[164:167], v[68:71]
    ds_read_b64_tr_b16 v[104:105], v35 offset:0
    ds_read_b64_tr_b16 v[106:107], v35 offset:4096
    s_waitcnt vmcnt(16)
    v_mfma_f32_16x16x32_bf16 v[44:47], v[84:87], a[172:175], v[44:47]
    ds_read_b64_tr_b16 v[72:73], v20 offset:0
    ds_read_b64_tr_b16 v[74:75], v20 offset:4096
    v_mfma_f32_16x16x32_bf16 v[52:55], v[88:91], a[172:175], v[52:55]
    ds_read_b64_tr_b16 v[76:77], v21 offset:0
    ds_read_b64_tr_b16 v[78:79], v21 offset:4096
    s_xor_b32 s73, s81, 0x2000
    s_waitcnt lgkmcnt(8)
    v_mfma_f32_16x16x32_bf16 v[60:63], v[92:95], a[172:175], v[60:63]
    buffer_load_dwordx4 a[208:211], v10, s[24:27], s73 offen offset:0 sc1
    ds_read_b64_tr_b16 v[80:81], v34 offset:2048
    ds_read_b64_tr_b16 v[82:83], v34 offset:6144
    v_mfma_f32_16x16x32_bf16 v[68:71], v[96:99], a[172:175], v[68:71]
    ds_read_b64_tr_b16 v[84:85], v35 offset:2048
    ds_read_b64_tr_b16 v[86:87], v35 offset:6144
    s_waitcnt vmcnt(10) lgkmcnt(10)
    v_mfma_f32_16x16x32_bf16 v[108:111], v[100:103], a[176:179], 0
    ds_read_b64_tr_b16 v[88:89], v20 offset:2048
    v_mfma_f32_16x16x32_bf16 v[112:115], v[100:103], a[180:183], 0
    ds_read_b64_tr_b16 v[90:91], v20 offset:6144
    s_waitcnt lgkmcnt(2)
    v_mfma_f32_16x16x32_bf16 v[116:119], v[104:107], a[176:179], 0
    buffer_load_dwordx4 a[212:215], v11, s[24:27], s73 offen offset:0 sc1
    v_mfma_f32_16x16x32_bf16 v[120:123], v[104:107], a[180:183], 0
    ds_read_b64_tr_b16 v[92:93], v21 offset:2048
    ds_read_b64_tr_b16 v[94:95], v21 offset:6144
    v_mfma_f32_16x16x32_bf16 v[124:127], v[72:75], a[176:179], 0
    buffer_load_dwordx4 a[216:219], v10, s[24:27], s73 offen offset:2048 sc1
    v_mfma_f32_16x16x32_bf16 v[128:131], v[72:75], a[180:183], 0
    s_barrier
    ds_read_b64_tr_b16 v[96:97], v34 offset:57344
    ds_read_b64_tr_b16 v[98:99], v34 offset:61440
    v_mfma_f32_16x16x32_bf16 v[132:135], v[76:79], a[176:179], 0
    buffer_load_dwordx4 a[220:223], v11, s[24:27], s73 offen offset:2048 sc1
    v_mfma_f32_16x16x32_bf16 v[136:139], v[76:79], a[180:183], 0
    ds_read_b64_tr_b16 v[100:101], v35 offset:57344
    ds_read_b64_tr_b16 v[102:103], v35 offset:61440
    s_add_u32 s72, s96, 0x30000
    s_add_u32 m0, s69, 0x22000
    s_waitcnt vmcnt(11)
    v_mfma_f32_16x16x32_bf16 v[108:111], v[80:83], a[184:187], v[108:111]
    buffer_load_dwordx4 v14, s[20:23], s72 offen offset:0 lds
    v_mfma_f32_16x16x32_bf16 v[112:115], v[80:83], a[188:191], v[112:115]
    ds_read_b64_tr_b16 v[104:105], v20 offset:57344
    ds_read_b64_tr_b16 v[106:107], v20 offset:61440
    v_mfma_f32_16x16x32_bf16 v[116:119], v[84:87], a[184:187], v[116:119]
    buffer_load_dwordx4 v15, s[20:23], s72 offen offset:1024 lds
    v_mfma_f32_16x16x32_bf16 v[120:123], v[84:87], a[188:191], v[120:123]
    ds_read_b64_tr_b16 v[72:73], v21 offset:57344
    ds_read_b64_tr_b16 v[74:75], v21 offset:61440
    s_waitcnt lgkmcnt(7)
    v_mfma_f32_16x16x32_bf16 v[124:127], v[88:91], a[184:187], v[124:127]
    buffer_load_dwordx4 v16, s[20:23], s72 offen offset:2048 lds
    v_mfma_f32_16x16x32_bf16 v[128:131], v[88:91], a[188:191], v[128:131]
    ds_read_b64_tr_b16 v[76:77], v34 offset:59392
    ds_read_b64_tr_b16 v[78:79], v34 offset:63488
    v_mfma_f32_16x16x32_bf16 v[132:135], v[92:95], a[184:187], v[132:135]
    buffer_load_dwordx4 v17, s[20:23], s72 offen offset:3072 lds
    v_mfma_f32_16x16x32_bf16 v[136:139], v[92:95], a[188:191], v[136:139]
    ds_read_b64_tr_b16 v[80:81], v35 offset:59392
    ds_read_b64_tr_b16 v[82:83], v35 offset:63488
    s_waitcnt vmcnt(13) lgkmcnt(8)
    v_mfma_f32_16x16x32_bf16 v[108:111], v[96:99], a[192:195], v[108:111]
    ds_read_b64_tr_b16 v[84:85], v20 offset:59392
    v_mfma_f32_16x16x32_bf16 v[112:115], v[96:99], a[196:199], v[112:115]
    ds_read_b64_tr_b16 v[86:87], v20 offset:63488
    v_mfma_f32_16x16x32_bf16 v[116:119], v[100:103], a[192:195], v[116:119]
    ds_read_b64_tr_b16 v[88:89], v21 offset:59392
    v_mfma_f32_16x16x32_bf16 v[120:123], v[100:103], a[196:199], v[120:123]
    ds_read_b64_tr_b16 v[90:91], v21 offset:63488
    s_waitcnt lgkmcnt(6)
    v_mfma_f32_16x16x32_bf16 v[124:127], v[104:107], a[192:195], v[124:127]
    s_xor_b32 s73, s81, 0x3000
    v_mfma_f32_16x16x32_bf16 v[128:131], v[104:107], a[196:199], v[128:131]
    buffer_load_dwordx4 a[224:227], v10, s[24:27], s73 offen offset:0 sc1
    v_bfe_u32 v228, v1, 4, 4
    v_mul_u32_u24 v228, 144, v228
    v_lshrrev_b32 v229, 8, v1
    v_lshl_add_u32 v228, v229, 3, v228
    s_mul_i32 s97, s64, 2304
    v_add_u32 v9, s97, v228
    v_lshrrev_b32 v228, 7, v1
    v_and_b32 v229, 0x70, v1
    v_lshl_add_u32 v3, v228, 10, v229
    v_mul_u32_u24 v228, 144, v228
    s_mul_i32 s97, s64, 2304
    v_add3_u32 v12, s97, v228, v229
    buffer_load_dwordx4 a[228:231], v11, s[24:27], s73 offen offset:0 sc1
    s_lshr_b32 s97, s96, 12
    v_xor_b32 v3, s97, v3
    v_add_u32 v6, 0x2000, v3
    s_andn2_b32 s89, s89, 64
    s_lshr_b32 s97, s96, 4
    s_add_u32 s89, s89, s97
    v_add_u32 v4, s69, v1
    v_xor_b32 v5, 0x2000, v4
    s_cmp_eq_u32 s96, 0
    s_cselect_b64 vcc, -1, 0
    v_cndmask_b32 v245, v253, v255, vcc
    v_cndmask_b32 v247, v255, v253, vcc
    v_cndmask_b32 v244, v252, v254, vcc
    v_cndmask_b32 v246, v254, v252, vcc
    buffer_load_dwordx4 a[232:235], v10, s[24:27], s73 offen offset:2048 sc1
    v_mul_f32 v40, v245, v40
    v_mul_f32 v41, v245, v41
    v_mul_f32 v42, v245, v42
    v_mul_f32 v43, v245, v43
    v_mul_f32 v44, v247, v44
    v_mul_f32 v45, v247, v45
    v_mul_f32 v46, v247, v46
    v_mul_f32 v47, v247, v47
    v_mul_f32 v48, v245, v48
    v_mul_f32 v49, v245, v49
    v_mul_f32 v50, v245, v50
    v_mul_f32 v51, v245, v51
    v_mul_f32 v52, v247, v52
    v_mul_f32 v53, v247, v53
    v_mul_f32 v54, v247, v54
    v_mul_f32 v55, v247, v55
    buffer_load_dwordx4 a[236:239], v11, s[24:27], s73 offen offset:2048 sc1
    v_mul_f32 v56, v245, v56
    v_mul_f32 v57, v245, v57
    v_mul_f32 v58, v245, v58
    v_mul_f32 v59, v245, v59
    s_waitcnt vmcnt(12)
    s_barrier
    ds_read_b64_tr_b16 v[92:93], v34 offset:16384
    ds_read_b64_tr_b16 v[94:95], v34 offset:20480
    v_mfma_f32_16x16x32_bf16 v[132:135], v[72:75], a[192:195], v[132:135]
    ds_read_b64_tr_b16 v[96:97], v35 offset:16384
    v_mfma_f32_16x16x32_bf16 v[136:139], v[72:75], a[196:199], v[136:139]
    ds_read_b64_tr_b16 v[98:99], v35 offset:20480
    v_mfma_f32_16x16x32_bf16 v[108:111], v[76:79], a[200:203], v[108:111]
    ds_read_b64_tr_b16 v[100:101], v20 offset:16384
    v_mfma_f32_16x16x32_bf16 v[112:115], v[76:79], a[204:207], v[112:115]
    ds_read_b64_tr_b16 v[102:103], v20 offset:20480
    s_waitcnt lgkmcnt(6)
    v_mfma_f32_16x16x32_bf16 v[116:119], v[80:83], a[200:203], v[116:119]
    ds_read_b64_tr_b16 v[104:105], v21 offset:16384
    v_mfma_f32_16x16x32_bf16 v[120:123], v[80:83], a[204:207], v[120:123]
    ds_read_b64_tr_b16 v[106:107], v21 offset:20480
    v_mfma_f32_16x16x32_bf16 v[124:127], v[84:87], a[200:203], v[124:127]
    ds_read_b64_tr_b16 v[72:73], v34 offset:18432
    v_mfma_f32_16x16x32_bf16 v[128:131], v[84:87], a[204:207], v[128:131]
    ds_read_b64_tr_b16 v[74:75], v34 offset:22528
    v_mfma_f32_16x16x32_bf16 v[132:135], v[88:91], a[200:203], v[132:135]
    ds_read_b64_tr_b16 v[76:77], v35 offset:18432
    v_mfma_f32_16x16x32_bf16 v[136:139], v[88:91], a[204:207], v[136:139]
    ds_read_b64_tr_b16 v[78:79], v35 offset:22528
    s_waitcnt vmcnt(10) lgkmcnt(8)
    v_mfma_f32_16x16x32_bf16 v[108:111], v[92:95], a[208:211], v[108:111]
    ds_read_b64_tr_b16 v[80:81], v20 offset:18432
    v_mfma_f32_16x16x32_bf16 v[112:115], v[92:95], a[212:215], v[112:115]
    ds_read_b64_tr_b16 v[82:83], v20 offset:22528
    v_mfma_f32_16x16x32_bf16 v[116:119], v[96:99], a[208:211], v[116:119]
    ds_read_b64_tr_b16 v[84:85], v21 offset:18432
    v_mfma_f32_16x16x32_bf16 v[120:123], v[96:99], a[212:215], v[120:123]
    ds_read_b64_tr_b16 v[86:87], v21 offset:22528
    s_waitcnt lgkmcnt(8)
    v_mfma_f32_16x16x32_bf16 v[124:127], v[100:103], a[208:211], v[124:127]
    v_mul_f32 v60, v247, v60
    v_mfma_f32_16x16x32_bf16 v[128:131], v[100:103], a[212:215], v[128:131]
    v_mul_f32 v61, v247, v61
    v_mul_f32 v62, v247, v62
    v_mul_f32 v63, v247, v63
    v_mul_f32 v64, v245, v64
    v_mul_f32 v65, v245, v65
    v_mul_f32 v66, v245, v66
    v_mul_f32 v67, v245, v67
    v_mul_f32 v68, v247, v68
    v_mul_f32 v69, v247, v69
    v_mul_f32 v70, v247, v70
    v_mul_f32 v71, v247, v71
    s_waitcnt vmcnt(4)
    s_barrier
    ds_read_b64_tr_b16 v[88:89], v36 offset:8192
    ds_read_b64_tr_b16 v[90:91], v36 offset:12288
    v_mfma_f32_16x16x32_bf16 v[132:135], v[104:107], a[208:211], v[132:135]
    ds_read_b64_tr_b16 v[92:93], v37 offset:8192
    v_mfma_f32_16x16x32_bf16 v[136:139], v[104:107], a[212:215], v[136:139]
    ds_read_b64_tr_b16 v[94:95], v37 offset:12288
    s_waitcnt lgkmcnt(4)
    v_mfma_f32_16x16x32_bf16 v[108:111], v[72:75], a[216:219], v[108:111]
    ds_read_b64_tr_b16 v[96:97], v36 offset:10240
    v_mfma_f32_16x16x32_bf16 v[112:115], v[72:75], a[220:223], v[112:115]
    ds_read_b64_tr_b16 v[98:99], v36 offset:14336
    v_mfma_f32_16x16x32_bf16 v[116:119], v[76:79], a[216:219], v[116:119]
    ds_read_b64_tr_b16 v[100:101], v37 offset:10240
    v_mfma_f32_16x16x32_bf16 v[120:123], v[76:79], a[220:223], v[120:123]
    ds_read_b64_tr_b16 v[102:103], v37 offset:14336
    v_mfma_f32_16x16x32_bf16 v[124:127], v[80:83], a[216:219], v[124:127]
    ds_read_b64_tr_b16 v[104:105], v22 offset:8192
    v_mfma_f32_16x16x32_bf16 v[128:131], v[80:83], a[220:223], v[128:131]
    ds_read_b64_tr_b16 v[106:107], v22 offset:12288
    v_mfma_f32_16x16x32_bf16 v[132:135], v[84:87], a[216:219], v[132:135]
    ds_read_b64_tr_b16 v[72:73], v23 offset:8192
    v_mfma_f32_16x16x32_bf16 v[136:139], v[84:87], a[220:223], v[136:139]
    ds_read_b64_tr_b16 v[74:75], v23 offset:12288
    s_waitcnt vmcnt(3) lgkmcnt(8)
    v_mfma_f32_16x16x32_bf16 v[108:111], v[88:91], a[224:227], v[108:111]
    ds_read_b64_tr_b16 v[76:77], v22 offset:10240
    v_mfma_f32_16x16x32_bf16 v[116:119], v[92:95], a[224:227], v[116:119]
    ds_read_b64_tr_b16 v[78:79], v22 offset:14336
    s_waitcnt vmcnt(1) lgkmcnt(6)
    v_mfma_f32_16x16x32_bf16 v[108:111], v[96:99], a[232:235], v[108:111]
    ds_read_b64_tr_b16 v[80:81], v23 offset:10240
    v_mfma_f32_16x16x32_bf16 v[116:119], v[100:103], a[232:235], v[116:119]
    ds_read_b64_tr_b16 v[82:83], v23 offset:14336
    s_waitcnt lgkmcnt(4)
    v_mfma_f32_16x16x32_bf16 v[124:127], v[104:107], a[224:227], v[124:127]
    s_nop 2
    v_fma_f32 v140, v244, v108, v40
    v_mfma_f32_16x16x32_bf16 v[132:135], v[72:75], a[224:227], v[132:135]
    v_fma_f32 v141, v244, v109, v41
    v_fma_f32 v142, v244, v110, v42
    v_fma_f32 v143, v244, v111, v43
    ds_write_b128 v4, v[140:143] offset:0
    s_waitcnt lgkmcnt(1)
    v_mfma_f32_16x16x32_bf16 v[124:127], v[76:79], a[232:235], v[124:127]
    v_fma_f32 v148, v244, v116, v48
    v_mfma_f32_16x16x32_bf16 v[132:135], v[80:83], a[232:235], v[132:135]
    v_fma_f32 v149, v244, v117, v49
    v_fma_f32 v150, v244, v118, v50
    v_fma_f32 v151, v244, v119, v51
    ds_write_b128 v4, v[148:151] offset:1024
    v_mfma_f32_16x16x32_bf16 v[112:115], v[88:91], a[228:231], v[112:115]
    s_nop 0
    v_fma_f32 v156, v244, v124, v56
    v_mfma_f32_16x16x32_bf16 v[120:123], v[92:95], a[228:231], v[120:123]
    v_fma_f32 v157, v244, v125, v57
    v_fma_f32 v158, v244, v126, v58
    v_fma_f32 v159, v244, v127, v59
    ds_write_b128 v4, v[156:159] offset:2048
    s_waitcnt vmcnt(0)
    v_mfma_f32_16x16x32_bf16 v[112:115], v[96:99], a[236:239], v[112:115]
    v_fma_f32 v164, v244, v132, v64
    v_mfma_f32_16x16x32_bf16 v[120:123], v[100:103], a[236:239], v[120:123]
    v_fma_f32 v165, v244, v133, v65
    v_fma_f32 v166, v244, v134, v66
    v_fma_f32 v167, v244, v135, v67
    ds_write_b128 v4, v[164:167] offset:3072
    v_mfma_f32_16x16x32_bf16 v[128:131], v[104:107], a[228:231], v[128:131]
    v_mfma_f32_16x16x32_bf16 v[136:139], v[72:75], a[228:231], v[136:139]
    v_mfma_f32_16x16x32_bf16 v[128:131], v[76:79], a[236:239], v[128:131]
    v_mfma_f32_16x16x32_bf16 v[136:139], v[80:83], a[236:239], v[136:139]
    s_waitcnt lgkmcnt(0)
    s_barrier
    ds_read_b128 v[108:111], v5 offset:2048
    ds_read_b128 v[116:119], v5 offset:3072
    ds_read_b128 v[124:127], v5 offset:0
    ds_read_b128 v[132:135], v5 offset:1024
    v_pk_fma_f32 v[144:145], v[246:247], v[112:113], v[44:45] op_sel_hi:[0,1,1]
    v_pk_fma_f32 v[146:147], v[246:247], v[114:115], v[46:47] op_sel_hi:[0,1,1]
    v_pk_fma_f32 v[152:153], v[246:247], v[120:121], v[52:53] op_sel_hi:[0,1,1]
    v_pk_fma_f32 v[154:155], v[246:247], v[122:123], v[54:55] op_sel_hi:[0,1,1]
    s_waitcnt lgkmcnt(3)
    v_pk_add_f32 v[144:145], v[144:145], v[108:109]
    v_pk_add_f32 v[146:147], v[146:147], v[110:111]
    v_cvt_pk_bf16_f32 v212, v144, v145
    v_cvt_pk_bf16_f32 v213, v146, v147
    ds_write_b64 v9, v[212:213] offset:16384
    s_waitcnt lgkmcnt(3)
    v_pk_add_f32 v[152:153], v[152:153], v[116:117]
    v_pk_add_f32 v[154:155], v[154:155], v[118:119]
    v_cvt_pk_bf16_f32 v214, v152, v153
    v_cvt_pk_bf16_f32 v215, v154, v155
    ds_write_b64 v9, v[214:215] offset:16416
    v_pk_fma_f32 v[160:161], v[246:247], v[128:129], v[60:61] op_sel_hi:[0,1,1]
    v_pk_fma_f32 v[162:163], v[246:247], v[130:131], v[62:63] op_sel_hi:[0,1,1]
    v_pk_fma_f32 v[168:169], v[246:247], v[136:137], v[68:69] op_sel_hi:[0,1,1]
    v_pk_fma_f32 v[170:171], v[246:247], v[138:139], v[70:71] op_sel_hi:[0,1,1]
    s_waitcnt lgkmcnt(2)
    v_pk_add_f32 v[160:161], v[160:161], v[124:125]
    v_pk_add_f32 v[162:163], v[162:163], v[126:127]
    v_cvt_pk_bf16_f32 v216, v160, v161
    v_cvt_pk_bf16_f32 v217, v162, v163
    ds_write_b64 v9, v[216:217] offset:16448
    v_pk_add_f32 v[168:169], v[168:169], v[132:133]
    v_pk_add_f32 v[170:171], v[170:171], v[134:135]
    v_cvt_pk_bf16_f32 v218, v168, v169
    v_cvt_pk_bf16_f32 v219, v170, v171
    ds_write_b64 v9, v[218:219] offset:16480
    ds_read_b128 v[220:223], v12 offset:16384
    ds_read_b128 v[224:227], v12 offset:17536
    s_waitcnt lgkmcnt(1)
    buffer_store_dwordx4 v[220:223], v3, s[28:31], s89 offen sc1 nt
    s_waitcnt lgkmcnt(0)
    buffer_store_dwordx4 v[224:227], v6, s[28:31], s89 offen sc1 nt
L_end:
    s_endpgm
L_slow:
    s_waitcnt vmcnt(0) lgkmcnt(0)
    s_nop 15
    s_nop 3
    s_atomic_add s86, s[24:25], s84 offset:0
    s_atomic_add s86, s[24:25], s84 offset:128
    s_lshl_b32 s56, s65, 2
    s_add_u32 s56, s56, s64
    s_min_u32 s56, s56, 8
    s_sub_u32 s56, 8, s56
    s_mov_b32 s59, 0
    s_lshl_b32 s60, s56, 11
    v_add_u32 v243, s60, v29
    s_mul_i32 s60, s56, 2560
    v_add_u32 v244, s60, v30
    v_mov_b32 v220, v204
    v_mov_b32 v221, v205
    v_mov_b32 v222, v206
    v_mov_b32 v223, v207
Ls_head:
    v_mov_b32 v240, 0xff61b1e6
    v_mov_b32 v172, 0
    v_mov_b32 v173, 0
    v_mov_b32 v174, 0
    v_mov_b32 v175, 0
    v_mov_b32 v176, 0
    v_mov_b32 v177, 0
    v_mov_b32 v178, 0
    v_mov_b32 v179, 0
    v_mov_b32 v180, 0
    v_mov_b32 v181, 0
    v_mov_b32 v182, 0
    v_mov_b32 v183, 0
    v_mov_b32 v184, 0
    v_mov_b32 v185, 0
    v_mov_b32 v186, 0
    v_mov_b32 v187, 0
    s_mov_b32 s58, 0
Ls_pass:
    s_mov_b32 s57, s56
    v_mov_b32 v241, v243
    v_mov_b32 v242, v244
Ls_tile:
    ds_read_b128 v[72:75], v241
    ds_read_b128 v[80:83], v242
    ds_read_b128 v[84:87], v242 offset:1280
    s_cmp_eq_u32 s57, 0
    s_cselect_b32 s60, -1, 0
    s_cmp_eq_u32 s57, 8
    s_cselect_b32 s61, -1, 0
    v_and_b32 v124, s60, v56
    v_and_or_b32 v124, v40, s61, v124
    v_and_b32 v125, s60, v57
    v_and_or_b32 v125, v41, s61, v125
    v_and_b32 v126, s60, v58
    v_and_or_b32 v126, v42, s61, v126
    v_and_b32 v127, s60, v59
    v_and_or_b32 v127, v43, s61, v127
    v_and_b32 v128, s60, v60
    v_and_or_b32 v128, v44, s61, v128
    v_and_b32 v129, s60, v61
    v_and_or_b32 v129, v45, s61, v129
    v_and_b32 v130, s60, v62
    v_and_or_b32 v130, v46, s61, v130
    v_and_b32 v131, s60, v63
    v_and_or_b32 v131, v47, s61, v131
    v_and_b32 v132, s60, v64
    v_and_or_b32 v132, v48, s61, v132
    v_and_b32 v133, s60, v65
    v_and_or_b32 v133, v49, s61, v133
    v_and_b32 v134, s60, v66
    v_and_or_b32 v134, v50, s61, v134
    v_and_b32 v135, s60, v67
    v_and_or_b32 v135, v51, s61, v135
    v_and_b32 v136, s60, v68
    v_and_or_b32 v136, v52, s61, v136
    v_and_b32 v137, s60, v69
    v_and_or_b32 v137, v53, s61, v137
    v_and_b32 v138, s60, v70
    v_and_or_b32 v138, v54, s61, v138
    v_and_b32 v139, s60, v71
    v_and_or_b32 v139, v55, s61, v139
    s_waitcnt lgkmcnt(2)
    s_nop 0
    v_mfma_f32_32x32x16_bf16 v[108:123], v[72:75], v[220:223], v[124:139]
    s_waitcnt vmcnt(0) lgkmcnt(0)
    s_nop 15
    s_nop 3
    s_cmp_eq_u32 s58, 0
    s_cbranch_scc0 Ls_p1
    v_max3_f32 v240, v240, v108, v109
    v_max3_f32 v240, v240, v110, v111
    v_max3_f32 v240, v240, v112, v113
    v_max3_f32 v240, v240, v114, v115
    v_max3_f32 v240, v240, v116, v117
    v_max3_f32 v240, v240, v118, v119
    v_max3_f32 v240, v240, v120, v121
    v_max3_f32 v240, v240, v122, v123
    s_branch Ls_next
Ls_p1:
    v_sub_f32 v108, v108, v240
    v_sub_f32 v109, v109, v240
    v_sub_f32 v110, v110, v240
    v_sub_f32 v111, v111, v240
    v_sub_f32 v112, v112, v240
    v_sub_f32 v113, v113, v240
    v_sub_f32 v114, v114, v240
    v_sub_f32 v115, v115, v240
    v_sub_f32 v116, v116, v240
    v_sub_f32 v117, v117, v240
    v_sub_f32 v118, v118, v240
    v_sub_f32 v119, v119, v240
    v_sub_f32 v120, v120, v240
    v_sub_f32 v121, v121, v240
    v_sub_f32 v122, v122, v240
    v_sub_f32 v123, v123, v240
    v_exp_f32 v188, v108
    v_exp_f32 v189, v109
    v_exp_f32 v190, v110
    v_exp_f32 v191, v111
    v_exp_f32 v192, v112
    v_exp_f32 v193, v113
    v_exp_f32 v194, v114
    v_exp_f32 v195, v115
    v_exp_f32 v196, v116
    v_exp_f32 v197, v117
    v_exp_f32 v198, v118
    v_exp_f32 v199, v119
    v_exp_f32 v200, v120
    v_exp_f32 v201, v121
    v_exp_f32 v202, v122
    v_exp_f32 v203, v123
    v_cvt_pk_bf16_f32 v212, v188, v189
    v_cvt_pk_bf16_f32 v213, v190, v191
    v_cvt_pk_bf16_f32 v214, v192, v193
    v_cvt_pk_bf16_f32 v215, v194, v195
    v_cvt_pk_bf16_f32 v216, v196, v197
    v_cvt_pk_bf16_f32 v217, v198, v199
    v_cvt_pk_bf16_f32 v218, v200, v201
    v_cvt_pk_bf16_f32 v219, v202, v203
    v_mfma_f32_32x32x16_bf16 v[172:187], v[80:83], v[212:215], v[172:187]
    s_nop 0
    v_mfma_f32_32x32x16_bf16 v[172:187], v[84:87], v[216:219], v[172:187]
Ls_next:
    s_waitcnt vmcnt(0) lgkmcnt(0)
    s_nop 15
    s_nop 3
    v_add_u32 v241, 2048, v241
    v_add_u32 v242, 2560, v242
    s_add_u32 s57, s57, 1
    s_cmp_le_u32 s57, 8
    s_cbranch_scc1 Ls_tile
    s_cmp_eq_u32 s58, 0
    s_cbranch_scc0 Ls_hdone
    v_mov_b32 v241, v240
    s_nop 1
    v_permlane32_swap_b32 v241, v240
    v_max_f32 v240, v240, v241
    s_mov_b32 s58, 1
    s_branch Ls_pass
Ls_hdone:
    s_cmp_eq_u32 s59, 0
    s_cbranch_scc0 Ls_done
    v_mov_b32 v140, v172
    v_mov_b32 v141, v173
    v_mov_b32 v142, v174
    v_mov_b32 v143, v175
    v_mov_b32 v144, v176
    v_mov_b32 v145, v177
    v_mov_b32 v146, v178
    v_mov_b32 v147, v179
    v_mov_b32 v148, v180
    v_mov_b32 v149, v181
    v_mov_b32 v150, v182
    v_mov_b32 v151, v183
    v_mov_b32 v152, v184
    v_mov_b32 v153, v185
    v_mov_b32 v154, v186
    v_mov_b32 v155, v187
    v_mov_b32 v220, v208
    v_mov_b32 v221, v209
    v_mov_b32 v222, v210
    v_mov_b32 v223, v211
    v_add_u32 v243, 1024, v243
    v_sub_u32 v244, v244, v30
    v_add_u32 v244, v244, v31
    s_mov_b32 s59, 1
    s_branch Ls_head
Ls_done:
    v_mov_b32 v156, v172
    v_mov_b32 v157, v173
    v_mov_b32 v158, v174
    v_mov_b32 v159, v175
    v_mov_b32 v160, v176
    v_mov_b32 v161, v177
    v_mov_b32 v162, v178
    v_mov_b32 v163, v179
    v_mov_b32 v164, v180
    v_mov_b32 v165, v181
    v_mov_b32 v166, v182
    v_mov_b32 v167, v183
    v_mov_b32 v168, v184
    v_mov_b32 v169, v185
    v_mov_b32 v170, v186
    v_mov_b32 v171, v187
    s_waitcnt vmcnt(0) lgkmcnt(0)
    s_nop 15
    s_nop 3
    v_rcp_f32 v230, v148
    s_nop 0
    v_mul_f32 v140, v140, v230
    v_mul_f32 v141, v141, v230
    v_mul_f32 v142, v142, v230
    v_mul_f32 v143, v143, v230
    v_mul_f32 v144, v144, v230
    v_mul_f32 v145, v145, v230
    v_mul_f32 v146, v146, v230
    v_mul_f32 v147, v147, v230
    v_cvt_pk_bf16_f32 v232, v140, v141
    v_cvt_pk_bf16_f32 v233, v142, v143
    v_cvt_pk_bf16_f32 v234, v144, v145
    v_cvt_pk_bf16_f32 v235, v146, v147
    buffer_load_dwordx4 v15, s[16:19], s72 offen offset:1024 lds
    buffer_load_dwordx4 v16, s[16:19], s72 offen offset:2048 lds
    buffer_load_dwordx4 v17, s[16:19], s72 offen offset:3072 lds
    s_xor_b32 s72, s3, 0x20000
    s_add_u32 s72, s72, s95
    s_add_u32 m0, s69, 0x10000
    s_nop 0
    buffer_load_dwordx4 v14, s[16:19], s72 offen offset:0 lds
    buffer_load_dwordx4 v15, s[16:19], s72 offen offset:1024 lds
    buffer_load_dwordx4 v16, s[16:19], s72 offen offset:2048 lds
    buffer_load_dwordx4 v17, s[16:19], s72 offen offset:3072 lds
    s_xor_b32 s72, s3, 0x30000
    s_add_u32 s72, s72, s95
    s_add_u32 m0, s69, 0x1e000
    s_nop 0
    buffer_load_dwordx4 v14, s[16:19], s72 offen offset:0 lds
    buffer_load_dwordx4 v15, s[16:19], s72 offen offset:1024 lds
    buffer_load_dwordx4 v16, s[16:19], s72 offen offset:2048 lds
    buffer_load_dwordx4 v17, s[16:19], s72 offen offset:3072 lds
    s_xor_b32 s72, s3, 0x40000
    s_add_u32 s72, s72, s95
    s_add_u32 m0, s69, 0x14000
    s_nop 0
    buffer_load_dwordx4 v14, s[16:19], s72 offen offset:0 lds
    buffer_load_dwordx4 v15, s[16:19], s72 offen offset:1024 lds
    buffer_load_dwordx4 v16, s[16:19], s72 offen offset:2048 lds
    s_load_dword s40, s[24:25], s85 glc
    buffer_load_dwordx4 v17, s[16:19], s72 offen offset:3072 lds
    s_xor_b32 s72, s3, 0x50000
    s_add_u32 s72, s72, s95
    s_add_u32 m0, s69, 0x22000
    s_nop 0
    buffer_load_dwordx4 v14, s[16:19], s72 offen offset:0 lds
    buffer_load_dwordx4 v15, s[16:19], s72 offen offset:1024 lds
    buffer_load_dwordx4 v16, s[16:19], s72 offen offset:2048 lds
    buffer_load_dwordx4 v17, s[16:19], s72 offen offset:3072 lds
Lp_h3s:
    s_waitcnt lgkmcnt(0)
    s_cmp_eq_u32 s40, 16
    s_cbranch_scc0 Lr_h3s
Ld_h3s:
    s_add_u32 s73, s1, s80
    buffer_load_dwordx4 a[0:3], v10, s[24:27], s73 offen offset:0 sc1
    buffer_load_dwordx4 a[4:7], v11, s[24:27], s73 offen offset:0 sc1
    buffer_load_dwordx4 a[8:11], v10, s[24:27], s73 offen offset:2048 sc1
    buffer_load_dwordx4 a[12:15], v11, s[24:27], s73 offen offset:2048 sc1
    s_xor_b32 s73, s1, 0x1000
    s_add_u32 s73, s73, s80
    buffer_load_dwordx4 a[16:19], v10, s[24:27], s73 offen offset:0 sc1
    buffer_load_dwordx4 a[20:23], v11, s[24:27], s73 offen offset:0 sc1
    buffer_load_dwordx4 a[24:27], v10, s[24:27], s73 offen offset:2048 sc1
    buffer_load_dwordx4 a[28:31], v11, s[24:27], s73 offen offset:2048 sc1
    s_xor_b32 s73, s1, 0x2000
    s_add_u32 s73, s73, s80
    buffer_load_dwordx4 a[32:35], v10, s[24:27], s73 offen offset:0 sc1
    buffer_load_dwordx4 a[36:39], v11, s[24:27], s73 offen offset:0 sc1
    buffer_load_dwordx4 a[40:43], v10, s[24:27], s73 offen offset:2048 sc1
    buffer_load_dwordx4 a[44:47], v11, s[24:27], s73 offen offset:2048 sc1
    s_xor_b32 s73, s1, 0x3000
    s_add_u32 s73, s73, s80
    buffer_load_dwordx4 a[48:51], v10, s[24:27], s73 offen offset:0 sc1
    buffer_load_dwordx4 a[52:55], v11, s[24:27], s73 offen offset:0 sc1
    buffer_load_dwordx4 a[56:59], v10, s[24:27], s73 offen offset:2048 sc1
    buffer_load_dwordx4 a[60:63], v11, s[24:27], s73 offen offset:2048 sc1
    s_xor_b32 s73, s1, 0x4000
    s_add_u32 s73, s73, s80
    buffer_load_dwordx4 a[64:67], v10, s[24:27], s73 offen offset:0 sc1
    buffer_load_dwordx4 a[68:71], v11, s[24:27], s73 offen offset:0 sc1
    buffer_load_dwordx4 a[72:75], v10, s[24:27], s73 offen offset:2048 sc1
    buffer_load_dwordx4 a[76:79], v11, s[24:27], s73 offen offset:2048 sc1
    s_xor_b32 s73, s1, 0x5000
    s_add_u32 s73, s73, s80
    buffer_load_dwordx4 a[80:83], v10, s[24:27], s73 offen offset:0 sc1
    buffer_load_dwordx4 a[84:87], v11, s[24:27], s73 offen offset:0 sc1
    buffer_load_dwordx4 a[88:91], v10, s[24:27], s73 offen offset:2048 sc1
    buffer_load_dwordx4 a[92:95], v11, s[24:27], s73 offen offset:2048 sc1
    s_xor_b32 s73, s1, 0x6000
    s_add_u32 s73, s73, s80
    buffer_load_dwordx4 a[96:99], v10, s[24:27], s73 offen offset:0 sc1
    buffer_load_dwordx4 a[100:103], v11, s[24:27], s73 offen offset:0 sc1
    buffer_load_dwordx4 a[104:107], v10, s[24:27], s73 offen offset:2048 sc1
    buffer_load_dwordx4 a[108:111], v11, s[24:27], s73 offen offset:2048 sc1
    s_xor_b32 s73, s1, 0x7000
    s_add_u32 s73, s73, s80
    buffer_load_dwordx4 a[112:115], v10, s[24:27], s73 offen offset:0 sc1
    buffer_load_dwordx4 a[116:119], v11, s[24:27], s73 offen offset:0 sc1
    buffer_load_dwordx4 a[120:123], v10, s[24:27], s73 offen offset:2048 sc1
    buffer_load_dwordx4 a[124:127], v11, s[24:27], s73 offen offset:2048 sc1
    s_add_u32 s73, s80, 0x8000
    buffer_load_dwordx4 a[128:131], v10, s[24:27], s73 offen offset:0 sc1
    buffer_load_dwordx4 a[132:135], v11, s[24:27], s73 offen offset:0 sc1
    buffer_load_dwordx4 a[136:139], v10, s[24:27], s73 offen offset:2048 sc1
    buffer_load_dwordx4 a[140:143], v11, s[24:27], s73 offen offset:2048 sc1
    s_add_u32 s73, s80, 0x9000
    buffer_load_dwordx4 a[144:147], v10, s[24:27], s73 offen offset:0 sc1
    buffer_load_dwordx4 a[148:151], v11, s[24:27], s73 offen offset:0 sc1
    buffer_store_dwordx4 v[232:235], v8, s[24:27], s79 offen offset:0 sc1
    s_waitcnt vmcnt(0) lgkmcnt(0)
    s_nop 15
    s_nop 3
    s_branch L_join
Lr_h3s:
    s_load_dword s40, s[24:25], s85 glc
    s_sub_u32 s90, s90, 1
    s_cbranch_scc0 Lp_h3s
    s_mov_b32 s90, 0
    s_waitcnt lgkmcnt(0)
    s_branch Ld_h3s
.section .rodata,"a"
.p2align 6
.amdhsa_kernel gated_mix__sliding_block__dense_activation_silu__prompt_kernel
  .amdhsa_next_free_vgpr 512
  .amdhsa_next_free_sgpr 102
  .amdhsa_accum_offset 256
  .amdhsa_group_segment_fixed_size 0
  .amdhsa_kernarg_size 80
  .amdhsa_user_sgpr_count 2
  .amdhsa_user_sgpr_kernarg_segment_ptr 1
  .amdhsa_system_sgpr_workgroup_id_x 1
.end_amdhsa_kernel
```
